```python
import torch

def _softmax(x, axis=-1):
    return torch.softmax(x, dim=axis)

def _gelu(x):
    return torch.nn.functional.gelu(x, approximate='tanh')

def _silu(x):
    return torch.nn.functional.silu(x)

def _sigmoid(x):
    return torch.sigmoid(x)

def _layernorm(x, axis=-1, eps=1e-05):
    m = x.mean(dim=axis, keepdim=True)
    v = x.var(dim=axis, keepdim=True, unbiased=False)
    return (x - m) / torch.sqrt(v + eps)

def _scatter_add(tgt, idx, src, axis=0):
    return tgt.clone().index_add_(axis, idx, src)

def _segment_sum(src, seg, n):
    out = torch.zeros((n,) + src.shape[1:], dtype=src.dtype)
    return out.index_add_(0, seg, src)

def _pad(x, pw):
    flat = tuple((v for pair in reversed(pw) for v in pair))
    return torch.nn.functional.pad(x, flat)
kernel_name = 'standalone__tree_speculative_verify_tree_attention_over_candidate_token_tree__sampling'

def setup_inputs():

    _w = lambda a: (lambda t: t.to(torch.bfloat16) if t.is_floating_point() else t)(torch.as_tensor(a))
    B, Hq, Hkv, T, C, D = (8, 32, 4, 32, 8192, 128)
    tree_mask = torch.zeros((B, T, T), dtype=float)
    for b in range(B):
        parent = torch.zeros(T, dtype=torch.int64)
        for i in range(1, T):
            parent[i] = int(torch.randint(0, i, (1,)).item())
        for i in range(T):
            j = i
            tree_mask[b, i, j] = 1.0
            while j > 0:
                j = parent[j]
                tree_mask[b, i, j] = 1.0
    return {'q': _w((lambda *s: torch.randn(*s, dtype=torch.bfloat16) * 0.8)(B, Hq, T, D)), 'k_cache': _w((lambda *s: torch.randn(*s, dtype=torch.bfloat16) * 0.8)(B, Hkv, C, D)), 'v_cache': _w((lambda *s: torch.randn(*s, dtype=torch.bfloat16) * 0.05)(B, Hkv, C, D)), 'k_tree': _w((lambda *s: torch.randn(*s, dtype=torch.bfloat16) * 0.8)(B, Hkv, T, D)), 'v_tree': _w((lambda *s: torch.randn(*s, dtype=torch.bfloat16) * 0.05)(B, Hkv, T, D)), 'tree_mask': _w(tree_mask)}

def reference(q, k_cache, v_cache, k_tree, v_tree, tree_mask):
    B, Hq, T, D = q.shape
    Hkv, C = (k_cache.shape[1], k_cache.shape[2])
    rep = Hq // Hkv
    kc = (lambda x, n, axis: torch.repeat_interleave(x, n, dim=axis))(k_cache, rep, axis=1)
    vc = (lambda x, n, axis: torch.repeat_interleave(x, n, dim=axis))(v_cache, rep, axis=1)
    kt = (lambda x, n, axis: torch.repeat_interleave(x, n, dim=axis))(k_tree, rep, axis=1)
    vt = (lambda x, n, axis: torch.repeat_interleave(x, n, dim=axis))(v_tree, rep, axis=1)
    k = torch.concatenate([kc, kt], axis=2)
    v = torch.concatenate([vc, vt], axis=2)
    scale = D ** (-0.5)
    scores = torch.einsum('bhqd,bhkd->bhqk', q, k) * scale
    ctx_mask = torch.ones((B, 1, T, C), dtype=scores.dtype)
    tm = tree_mask[:, None, :, :].clone()
    full_mask = torch.concatenate([ctx_mask, tm], axis=-1)
    scores = scores + (1.0 - full_mask) * -1000000000.0
    p = _softmax(scores, axis=-1)
    return torch.einsum('bhqk,bhkd->bhqd', p, v)
```

```asm
; @launch grid=(256,1,1) block=(256,1,1) lds=147456
.amdgcn_target "amdgcn-amd-amdhsa--gfx950"
.text
.globl standalone__tree_speculative_verify_tree_attention_over_candidate_token_tree__sampling_kernel
.p2align 8
.type standalone__tree_speculative_verify_tree_attention_over_candidate_token_tree__sampling_kernel,@function
standalone__tree_speculative_verify_tree_attention_over_candidate_token_tree__sampling_kernel:
    s_cmp_ge_u32 s2, 256
    s_cbranch_scc1 MAIN_END
    s_load_dwordx16 s[8:23], s[0:1], 0
    s_load_dwordx2 s[24:25], s[0:1], 64
    s_getpc_b64 s[4:5]
PC_HERE:
    v_lshlrev_b32 v2, 7, v0
    v_min_u32 v2, CODE_END-PC_HERE-4, v2
    global_load_dword v14, v2, s[4:5]
    s_lshr_b32 s3, s2, 6
    s_lshl_b32 s3, s3, 3
    s_and_b32 s4, s2, 7
    s_add_u32 s56, s3, s4
    s_lshr_b32 s57, s2, 3
    s_and_b32 s57, s57, 7
    v_lshrrev_b32 v1, 6, v0
    v_and_b32 v0, 63, v0
    v_readfirstlane_b32 s44, v1
    v_and_b32 v4, 15, v0
    v_lshrrev_b32 v5, 4, v0
    s_lshl_b32 s45, s44, 11
    v_lshl_add_u32 v33, v1, 3, v5
    v_and_b32 v34, 15, v33
    v_xor_b32 v34, v34, v4
    v_lshlrev_b32 v35, 8, v33
    v_lshl_add_u32 v28, v34, 4, v35
    v_xor_b32 v34, 4, v34
    v_lshl_add_u32 v29, v34, 4, v35
    v_lshlrev_b32 v34, 1, v5
    v_xor_b32 v34, v34, v4
    v_lshl_add_u32 v30, v34, 4, v35
    v_xor_b32 v34, 8, v34
    v_lshl_add_u32 v31, v34, 4, v35
    v_lshl_add_u32 v33, v1, 6, v5
    v_lshlrev_b32 v35, 8, v33
    v_xor_b32 v34, v4, v5
    v_xor_b32 v36, 0, v34
    v_lshl_add_u32 v40, v36, 4, v35
    v_xor_b32 v36, 4, v34
    v_lshl_add_u32 v41, v36, 4, v35
    v_xor_b32 v36, 8, v34
    v_lshl_add_u32 v42, v36, 4, v35
    v_xor_b32 v36, 12, v34
    v_lshl_add_u32 v43, v36, 4, v35
    s_lshl_b32 s3, s56, 21
    s_lshl_b32 s4, s57, 18
    s_add_u32 s3, s3, s4
    s_lshl_b32 s4, s56, 16
    s_and_b32 s5, s44, 1
    s_lshl_b32 s5, s5, 14
    s_lshr_b32 s7, s44, 1
    s_lshl_b32 s7, s7, 16
    s_add_u32 s5, s5, s7
    s_add_u32 s5, s5, 0x8000
    s_and_b32 s46, s2, 31
    s_lshl_b32 s46, s46, 13
    s_mov_b32 s47, s46
    s_mov_b32 s55, 1
    s_mov_b32 s26, s45
    s_add_u32 s27, s45, 0x8000
    s_waitcnt lgkmcnt(0)
    s_add_u32 s28, s10, s3
    s_addc_u32 s29, s11, 0
    s_mov_b32 s30, 0x40000
    s_mov_b32 s31, 0x00020000
    s_add_u32 m0, s26, 0
    s_add_u32 s36, s8, s4
    s_addc_u32 s37, s9, 0
    s_mov_b32 s38, 0x10000
    s_mov_b32 s39, 0x00020000
    buffer_load_dwordx4 v28, s[28:31], s47 offen nt lds
    buffer_load_dwordx4 v29, s[28:31], s47 offen offset:1024 nt lds
    s_add_u32 m0, s5, 0
    s_movk_i32 s7, 0
    buffer_load_dwordx4 v40, s[36:39], s7 offen offset:0 lds
    buffer_load_dwordx4 v41, s[36:39], s7 offen offset:1024 lds
    buffer_load_dwordx4 v42, s[36:39], s7 offen offset:2048 lds
    buffer_load_dwordx4 v43, s[36:39], s7 offen offset:3072 lds
    s_add_u32 m0, s5, 4096
    s_movk_i32 s7, 4096
    buffer_load_dwordx4 v40, s[36:39], s7 offen offset:0 lds
    buffer_load_dwordx4 v41, s[36:39], s7 offen offset:1024 lds
    buffer_load_dwordx4 v42, s[36:39], s7 offen offset:2048 lds
    buffer_load_dwordx4 v43, s[36:39], s7 offen offset:3072 lds
    s_add_u32 s32, s12, s3
    s_addc_u32 s33, s13, 0
    s_mov_b32 s34, 0x40000
    s_mov_b32 s35, 0x00020000
    s_mov_b32 s40, s24
    s_mov_b32 s41, s25
    s_mov_b32 s42, 0x2000000
    s_mov_b32 s43, 0x00020000
    v_lshlrev_b32 v6, 8, v4
    v_xor_b32 v7, v5, v4
    v_xor_b32 v33, 0, v7
    v_lshl_add_u32 v16, v33, 4, v6
    v_add_u32 v48, s5, v16
    v_xor_b32 v33, 4, v7
    v_lshl_add_u32 v17, v33, 4, v6
    v_add_u32 v49, s5, v17
    v_xor_b32 v33, 8, v7
    v_lshl_add_u32 v18, v33, 4, v6
    v_add_u32 v50, s5, v18
    v_xor_b32 v33, 12, v7
    v_lshl_add_u32 v19, v33, 4, v6
    v_add_u32 v51, s5, v19
    s_mov_b32 s92, 0x3e0293ee
    s_mov_b32 s96, 0x3e0293ee
    s_mov_b32 s97, 0x3e0293ee
    s_add_u32 m0, s5, 8192
    s_movk_i32 s7, 8192
    buffer_load_dwordx4 v40, s[36:39], s7 offen offset:0 lds
    buffer_load_dwordx4 v41, s[36:39], s7 offen offset:1024 lds
    buffer_load_dwordx4 v42, s[36:39], s7 offen offset:2048 lds
    buffer_load_dwordx4 v43, s[36:39], s7 offen offset:3072 lds
    s_add_u32 m0, s5, 12288
    s_movk_i32 s7, 12288
    buffer_load_dwordx4 v40, s[36:39], s7 offen offset:0 lds
    buffer_load_dwordx4 v41, s[36:39], s7 offen offset:1024 lds
    buffer_load_dwordx4 v42, s[36:39], s7 offen offset:2048 lds
    buffer_load_dwordx4 v43, s[36:39], s7 offen offset:3072 lds
    s_lshl_b32 s3, s56, 3
    s_add_u32 s3, s3, s57
    s_lshl_b32 s50, s3, 7
    s_add_u32 s50, s50, 0x1100000
    v_and_b32 v33, 31, v0
    v_lshlrev_b32 v33, 2, v33
    v_mov_b32 v34, 0
    s_cmp_lg_u32 s44, 0
    s_cbranch_scc1 SKIP_RESET
    buffer_store_dword v34, v33, s[40:43], s50 offen sc1
SKIP_RESET:
    s_mov_b32 s54, s47
    s_add_u32 s46, s46, 8192
    s_and_b32 s46, s46, 0x3ffff
    s_cmp_lt_u32 s55, 32
    s_cselect_b32 s47, s46, 0x40000
    s_add_u32 m0, s26, 8192
    s_add_u32 s55, s55, 1
    buffer_load_dwordx4 v28, s[28:31], s47 offen nt lds
    buffer_load_dwordx4 v29, s[28:31], s47 offen offset:1024 nt lds
    s_add_u32 m0, s26, 65536
    s_nop 0
    buffer_load_dwordx4 v30, s[32:35], s54 offen nt lds
    buffer_load_dwordx4 v31, s[32:35], s54 offen offset:1024 nt lds
    v_lshrrev_b32 v33, 2, v4
    v_lshl_add_u32 v34, v5, 2, v33
    v_and_b32 v35, 7, v34
    v_lshlrev_b32 v34, 8, v34
    v_and_b32 v36, 3, v4
    v_lshl_add_u32 v34, v36, 3, v34
    v_add_u32 v34, 0x10000, v34
    v_xor_b32 v36, 0, v35
    v_lshl_add_u32 v20, v36, 5, v34
    v_xor_b32 v36, 1, v35
    v_lshl_add_u32 v21, v36, 5, v34
    v_xor_b32 v36, 2, v35
    v_lshl_add_u32 v22, v36, 5, v34
    v_xor_b32 v36, 3, v35
    v_lshl_add_u32 v23, v36, 5, v34
    v_xor_b32 v36, 4, v35
    v_lshl_add_u32 v24, v36, 5, v34
    v_xor_b32 v36, 5, v35
    v_lshl_add_u32 v25, v36, 5, v34
    v_xor_b32 v36, 6, v35
    v_lshl_add_u32 v26, v36, 5, v34
    v_xor_b32 v36, 7, v35
    v_lshl_add_u32 v27, v36, 5, v34
    s_and_b32 s93, s57, 6
    s_lshr_b32 s3, s44, 1
    s_add_u32 s93, s93, s3
    s_and_b32 s94, s57, 1
    s_and_b32 s95, s44, 1
    s_lshl_b32 s3, s94, 10
    v_lshlrev_b32 v33, 6, v4
    v_lshl_add_u32 v33, v5, 3, v33
    v_add_u32 v44, s3, v33
    s_lshl_b32 s3, s56, 13
    s_add_u32 s72, s14, s3
    s_addc_u32 s73, s15, 0
    s_mov_b32 s74, 0x2000
    s_mov_b32 s75, 0x00020000
    s_add_u32 s76, s16, s3
    s_addc_u32 s77, s17, 0
    s_mov_b32 s78, 0x2000
    s_mov_b32 s79, 0x00020000
    s_lshr_b32 s3, s56, 2
    s_lshl_b32 s3, s3, 11
    s_add_u32 s80, s18, s3
    s_addc_u32 s81, s19, 0
    s_mov_b32 s82, 0x800
    s_mov_b32 s83, 0x00020000
    s_mov_b32 s84, s22
    s_mov_b32 s85, s23
    s_mov_b32 s86, 0x100
    s_mov_b32 s87, 0x00020000
    s_add_u32 s88, s20, s4
    s_addc_u32 s89, s21, 0
    s_mov_b32 s90, 0x10000
    s_mov_b32 s91, 0x00020000
    s_mov_b32 s48, 0x40004000
    v_mov_b32 v8, 0x3f803f80
    v_mov_b32 v9, 0x3f803f80
    v_mov_b32 v10, 0x3f803f80
    v_mov_b32 v11, 0x3f803f80
    s_mov_b32 s51, 7
    s_and_b32 s3, s93, 3
    s_lshl_b32 s3, s3, 13
    s_lshr_b32 s4, s93, 2
    s_lshl_b32 s4, s4, 16
    s_add_u32 s3, s3, s4
    s_lshl_b32 s4, s94, 12
    s_add_u32 s3, s3, s4
    s_add_u32 s3, s3, 0x8000
    v_add_u32 v52, s3, v16
    v_add_u32 v53, s3, v17
    v_add_u32 v54, s3, v18
    v_add_u32 v55, s3, v19
    v_lshlrev_b32 v46, 4, v0
    v_lshlrev_b32 v47, 3, v4
    s_lshl_b32 s3, s56, 3
    s_lshl_b32 s4, s44, 1
    s_add_u32 s3, s3, s4
    s_lshl_b32 s4, s3, 3
    s_add_u32 s4, s4, s57
    s_lshl_b32 s58, s4, 13
    s_add_u32 s59, s58, 4096
    s_add_u32 s64, s58, 0x10000
    s_add_u32 s65, s58, 0x11000
    s_lshl_b32 s68, s4, 8
    s_add_u32 s68, s68, 0x1000000
    s_lshl_b32 s69, s3, 7
    s_add_u32 s69, s69, 0x1100000
    s_lshl_b32 s7, s56, 2
    s_waitcnt vmcnt(16)
    ds_read_b128 v[112:115], v48 offset:0
    ds_read_b128 v[116:119], v49 offset:0
    ds_read_b128 v[120:123], v50 offset:0
    ds_read_b128 v[124:127], v51 offset:0
    s_barrier
    ds_read_b128 a[128:131], v16 offset:0
    ds_read_b128 a[132:135], v17 offset:0
    ds_read_b128 a[136:139], v18 offset:0
    ds_read_b128 a[140:143], v19 offset:0
    ds_read_b128 a[144:147], v16 offset:4096
    ds_read_b128 a[148:151], v17 offset:4096
    ds_read_b128 a[152:155], v18 offset:4096
    ds_read_b128 a[156:159], v19 offset:4096
    s_waitcnt lgkmcnt(11)
    v_lshlrev_b32 v32, 16, v112
    v_and_b32 v33, 0xffff0000, v112
    v_mul_f32 v32, s92, v32
    v_mul_f32 v33, s92, v33
    v_cvt_pk_bf16_f32 v112, v32, v33
    v_lshlrev_b32 v34, 16, v113
    v_and_b32 v35, 0xffff0000, v113
    v_mul_f32 v34, s92, v34
    v_mul_f32 v35, s92, v35
    v_cvt_pk_bf16_f32 v113, v34, v35
    v_lshlrev_b32 v36, 16, v114
    v_and_b32 v37, 0xffff0000, v114
    v_mul_f32 v36, s92, v36
    v_mul_f32 v37, s92, v37
    v_cvt_pk_bf16_f32 v114, v36, v37
    v_lshlrev_b32 v38, 16, v115
    v_and_b32 v39, 0xffff0000, v115
    v_mul_f32 v38, s92, v38
    v_mul_f32 v39, s92, v39
    v_cvt_pk_bf16_f32 v115, v38, v39
    s_waitcnt lgkmcnt(10)
    v_lshlrev_b32 v32, 16, v116
    v_and_b32 v33, 0xffff0000, v116
    v_mul_f32 v32, s92, v32
    v_mul_f32 v33, s92, v33
    v_cvt_pk_bf16_f32 v116, v32, v33
    v_lshlrev_b32 v34, 16, v117
    v_and_b32 v35, 0xffff0000, v117
    v_mul_f32 v34, s92, v34
    v_mul_f32 v35, s92, v35
    v_cvt_pk_bf16_f32 v117, v34, v35
    v_lshlrev_b32 v36, 16, v118
    v_and_b32 v37, 0xffff0000, v118
    v_mul_f32 v36, s92, v36
    v_mul_f32 v37, s92, v37
    v_cvt_pk_bf16_f32 v118, v36, v37
    v_lshlrev_b32 v38, 16, v119
    v_and_b32 v39, 0xffff0000, v119
    v_mul_f32 v38, s92, v38
    v_mul_f32 v39, s92, v39
    v_cvt_pk_bf16_f32 v119, v38, v39
    s_waitcnt vmcnt(12)
    ds_read_b128 v[128:131], v48 offset:4096
    ds_read_b128 v[132:135], v49 offset:4096
    ds_read_b128 v[136:139], v50 offset:4096
    ds_read_b128 v[140:143], v51 offset:4096
    s_mov_b32 s54, s47
    s_add_u32 s46, s46, 8192
    s_and_b32 s46, s46, 0x3ffff
    s_cmp_lt_u32 s55, 32
    s_cselect_b32 s47, s46, 0x40000
    s_add_u32 m0, s26, 16384
    s_add_u32 s55, s55, 1
    buffer_load_dwordx4 v28, s[28:31], s47 offen nt lds
    buffer_load_dwordx4 v29, s[28:31], s47 offen offset:1024 nt lds
    s_waitcnt lgkmcnt(13)
    v_lshlrev_b32 v32, 16, v120
    v_and_b32 v33, 0xffff0000, v120
    v_mul_f32 v32, s92, v32
    v_mul_f32 v33, s92, v33
    v_cvt_pk_bf16_f32 v120, v32, v33
    v_lshlrev_b32 v34, 16, v121
    v_and_b32 v35, 0xffff0000, v121
    v_mul_f32 v34, s92, v34
    v_mul_f32 v35, s92, v35
    v_cvt_pk_bf16_f32 v121, v34, v35
    v_lshlrev_b32 v36, 16, v122
    v_and_b32 v37, 0xffff0000, v122
    v_mul_f32 v36, s92, v36
    v_mul_f32 v37, s92, v37
    v_cvt_pk_bf16_f32 v122, v36, v37
    v_lshlrev_b32 v38, 16, v123
    v_and_b32 v39, 0xffff0000, v123
    v_mul_f32 v38, s92, v38
    v_mul_f32 v39, s92, v39
    v_cvt_pk_bf16_f32 v123, v38, v39
    s_add_u32 m0, s26, 73728
    s_nop 0
    buffer_load_dwordx4 v30, s[32:35], s54 offen nt lds
    buffer_load_dwordx4 v31, s[32:35], s54 offen offset:1024 nt lds
    s_waitcnt lgkmcnt(12)
    v_lshlrev_b32 v32, 16, v124
    v_and_b32 v33, 0xffff0000, v124
    v_mul_f32 v32, s92, v32
    v_mul_f32 v33, s92, v33
    v_cvt_pk_bf16_f32 v124, v32, v33
    v_lshlrev_b32 v34, 16, v125
    v_and_b32 v35, 0xffff0000, v125
    v_mul_f32 v34, s92, v34
    v_mul_f32 v35, s92, v35
    v_cvt_pk_bf16_f32 v125, v34, v35
    v_lshlrev_b32 v36, 16, v126
    v_and_b32 v37, 0xffff0000, v126
    v_mul_f32 v36, s92, v36
    v_mul_f32 v37, s92, v37
    v_cvt_pk_bf16_f32 v126, v36, v37
    v_lshlrev_b32 v38, 16, v127
    v_and_b32 v39, 0xffff0000, v127
    v_mul_f32 v38, s92, v38
    v_mul_f32 v39, s92, v39
    v_cvt_pk_bf16_f32 v127, v38, v39
    s_mov_b32 s54, s47
    s_add_u32 s46, s46, 8192
    s_and_b32 s46, s46, 0x3ffff
    s_cmp_lt_u32 s55, 32
    s_cselect_b32 s47, s46, 0x40000
    s_add_u32 m0, s26, 24576
    s_add_u32 s55, s55, 1
    buffer_load_dwordx4 v28, s[28:31], s47 offen nt lds
    buffer_load_dwordx4 v29, s[28:31], s47 offen offset:1024 nt lds
    s_waitcnt lgkmcnt(4)
    s_waitcnt lgkmcnt(3)
    v_lshlrev_b32 v32, 16, v128
    v_and_b32 v33, 0xffff0000, v128
    v_mul_f32 v32, s92, v32
    v_mul_f32 v33, s92, v33
    v_cvt_pk_bf16_f32 v128, v32, v33
    v_lshlrev_b32 v34, 16, v129
    v_and_b32 v35, 0xffff0000, v129
    v_mul_f32 v34, s92, v34
    v_mul_f32 v35, s92, v35
    v_mfma_f32_16x16x32_bf16 v[80:83], a[128:131], v[112:115], 0
    v_cvt_pk_bf16_f32 v129, v34, v35
    v_lshlrev_b32 v36, 16, v130
    v_and_b32 v37, 0xffff0000, v130
    v_mul_f32 v36, s92, v36
    v_mul_f32 v37, s92, v37
    v_cvt_pk_bf16_f32 v130, v36, v37
    v_lshlrev_b32 v38, 16, v131
    v_and_b32 v39, 0xffff0000, v131
    v_mul_f32 v38, s92, v38
    v_mfma_f32_16x16x32_bf16 v[80:83], a[132:135], v[116:119], v[80:83]
    v_mul_f32 v39, s92, v39
    v_cvt_pk_bf16_f32 v131, v38, v39
    s_add_u32 m0, s26, 81920
    s_nop 0
    buffer_load_dwordx4 v30, s[32:35], s54 offen nt lds
    buffer_load_dwordx4 v31, s[32:35], s54 offen offset:1024 nt lds
    s_waitcnt lgkmcnt(2)
    v_lshlrev_b32 v32, 16, v132
    v_and_b32 v33, 0xffff0000, v132
    v_mul_f32 v32, s92, v32
    v_mul_f32 v33, s92, v33
    v_cvt_pk_bf16_f32 v132, v32, v33
    v_lshlrev_b32 v34, 16, v133
    v_and_b32 v35, 0xffff0000, v133
    v_mul_f32 v34, s92, v34
    v_mul_f32 v35, s92, v35
    v_mfma_f32_16x16x32_bf16 v[80:83], a[136:139], v[120:123], v[80:83]
    v_cvt_pk_bf16_f32 v133, v34, v35
    v_lshlrev_b32 v36, 16, v134
    v_and_b32 v37, 0xffff0000, v134
    v_mul_f32 v36, s92, v36
    v_mul_f32 v37, s92, v37
    v_cvt_pk_bf16_f32 v134, v36, v37
    v_lshlrev_b32 v38, 16, v135
    v_and_b32 v39, 0xffff0000, v135
    v_mul_f32 v38, s92, v38
    v_mfma_f32_16x16x32_bf16 v[80:83], a[140:143], v[124:127], v[80:83]
    v_mul_f32 v39, s92, v39
    v_cvt_pk_bf16_f32 v135, v38, v39
    s_waitcnt vmcnt(16)
    ds_read_b128 v[144:147], v48 offset:8192
    ds_read_b128 v[148:151], v49 offset:8192
    ds_read_b128 v[152:155], v50 offset:8192
    ds_read_b128 v[156:159], v51 offset:8192
    s_add_u32 m0, s45, 139264
    s_nop 0
    buffer_load_dwordx4 v28, s[72:75], 0 offen lds
    buffer_load_dwordx4 v29, s[72:75], 0 offen offset:1024 lds
    s_waitcnt lgkmcnt(5)
    v_lshlrev_b32 v32, 16, v136
    v_and_b32 v33, 0xffff0000, v136
    v_mul_f32 v32, s92, v32
    v_mul_f32 v33, s92, v33
    v_cvt_pk_bf16_f32 v136, v32, v33
    v_lshlrev_b32 v34, 16, v137
    v_and_b32 v35, 0xffff0000, v137
    v_mul_f32 v34, s92, v34
    v_mul_f32 v35, s92, v35
    v_mfma_f32_16x16x32_bf16 v[84:87], a[144:147], v[112:115], 0
    v_cvt_pk_bf16_f32 v137, v34, v35
    v_lshlrev_b32 v36, 16, v138
    v_and_b32 v37, 0xffff0000, v138
    v_mul_f32 v36, s92, v36
    v_mul_f32 v37, s92, v37
    v_cvt_pk_bf16_f32 v138, v36, v37
    v_lshlrev_b32 v38, 16, v139
    v_and_b32 v39, 0xffff0000, v139
    v_mul_f32 v38, s92, v38
    v_mfma_f32_16x16x32_bf16 v[84:87], a[148:151], v[116:119], v[84:87]
    v_mul_f32 v39, s92, v39
    v_cvt_pk_bf16_f32 v139, v38, v39
    s_add_u32 m0, s45, 131072
    s_nop 0
    buffer_load_dwordx4 v30, s[76:79], 0 offen lds
    buffer_load_dwordx4 v31, s[76:79], 0 offen offset:1024 lds
    s_waitcnt lgkmcnt(4)
    v_lshlrev_b32 v32, 16, v140
    v_and_b32 v33, 0xffff0000, v140
    v_mul_f32 v32, s92, v32
    v_mul_f32 v33, s92, v33
    v_cvt_pk_bf16_f32 v140, v32, v33
    v_lshlrev_b32 v34, 16, v141
    v_and_b32 v35, 0xffff0000, v141
    v_mul_f32 v34, s92, v34
    v_mul_f32 v35, s92, v35
    v_mfma_f32_16x16x32_bf16 v[84:87], a[152:155], v[120:123], v[84:87]
    v_cvt_pk_bf16_f32 v141, v34, v35
    v_lshlrev_b32 v36, 16, v142
    v_and_b32 v37, 0xffff0000, v142
    v_mul_f32 v36, s92, v36
    v_mul_f32 v37, s92, v37
    v_cvt_pk_bf16_f32 v142, v36, v37
    v_lshlrev_b32 v38, 16, v143
    v_and_b32 v39, 0xffff0000, v143
    v_mul_f32 v38, s92, v38
    v_mfma_f32_16x16x32_bf16 v[84:87], a[156:159], v[124:127], v[84:87]
    v_mul_f32 v39, s92, v39
    v_cvt_pk_bf16_f32 v143, v38, v39
    buffer_load_dwordx2 v[40:41], v44, s[80:83], 0 offen
    buffer_load_dwordx2 v[42:43], v44, s[80:83], 0 offen offset:32
    s_waitcnt lgkmcnt(3)
    v_lshlrev_b32 v32, 16, v144
    v_and_b32 v33, 0xffff0000, v144
    v_mul_f32 v32, s92, v32
    v_mul_f32 v33, s92, v33
    v_cvt_pk_bf16_f32 v144, v32, v33
    v_lshlrev_b32 v34, 16, v145
    v_and_b32 v35, 0xffff0000, v145
    v_mul_f32 v34, s92, v34
    v_mul_f32 v35, s92, v35
    v_mfma_f32_16x16x32_bf16 v[88:91], a[128:131], v[128:131], 0
    v_cvt_pk_bf16_f32 v145, v34, v35
    v_lshlrev_b32 v36, 16, v146
    v_and_b32 v37, 0xffff0000, v146
    v_mul_f32 v36, s92, v36
    v_mul_f32 v37, s92, v37
    v_cvt_pk_bf16_f32 v146, v36, v37
    v_lshlrev_b32 v38, 16, v147
    v_and_b32 v39, 0xffff0000, v147
    v_mul_f32 v38, s92, v38
    v_mfma_f32_16x16x32_bf16 v[88:91], a[132:135], v[132:135], v[88:91]
    v_mul_f32 v39, s92, v39
    v_cvt_pk_bf16_f32 v147, v38, v39
    s_waitcnt lgkmcnt(2)
    v_lshlrev_b32 v32, 16, v148
    v_and_b32 v33, 0xffff0000, v148
    v_mul_f32 v32, s92, v32
    v_mul_f32 v33, s92, v33
    v_cvt_pk_bf16_f32 v148, v32, v33
    v_lshlrev_b32 v34, 16, v149
    v_and_b32 v35, 0xffff0000, v149
    v_mul_f32 v34, s92, v34
    v_mul_f32 v35, s92, v35
    v_mfma_f32_16x16x32_bf16 v[88:91], a[136:139], v[136:139], v[88:91]
    v_cvt_pk_bf16_f32 v149, v34, v35
    v_lshlrev_b32 v36, 16, v150
    v_and_b32 v37, 0xffff0000, v150
    v_mul_f32 v36, s92, v36
    v_mul_f32 v37, s92, v37
    v_cvt_pk_bf16_f32 v150, v36, v37
    v_lshlrev_b32 v38, 16, v151
    v_and_b32 v39, 0xffff0000, v151
    v_mul_f32 v38, s92, v38
    v_mfma_f32_16x16x32_bf16 v[88:91], a[140:143], v[140:143], v[88:91]
    v_mul_f32 v39, s92, v39
    v_cvt_pk_bf16_f32 v151, v38, v39
    s_waitcnt vmcnt(18)
    ds_read_b128 v[160:163], v48 offset:12288
    ds_read_b128 v[164:167], v49 offset:12288
    ds_read_b128 v[168:171], v50 offset:12288
    ds_read_b128 v[172:175], v51 offset:12288
    s_waitcnt lgkmcnt(5)
    v_lshlrev_b32 v32, 16, v152
    v_and_b32 v33, 0xffff0000, v152
    v_mul_f32 v32, s92, v32
    v_mul_f32 v33, s92, v33
    v_cvt_pk_bf16_f32 v152, v32, v33
    v_lshlrev_b32 v34, 16, v153
    v_and_b32 v35, 0xffff0000, v153
    v_mul_f32 v34, s92, v34
    v_mul_f32 v35, s92, v35
    v_mfma_f32_16x16x32_bf16 v[92:95], a[144:147], v[128:131], 0
    v_cvt_pk_bf16_f32 v153, v34, v35
    v_lshlrev_b32 v36, 16, v154
    v_and_b32 v37, 0xffff0000, v154
    v_mul_f32 v36, s92, v36
    v_mul_f32 v37, s92, v37
    v_cvt_pk_bf16_f32 v154, v36, v37
    v_lshlrev_b32 v38, 16, v155
    v_and_b32 v39, 0xffff0000, v155
    v_mul_f32 v38, s92, v38
    v_mfma_f32_16x16x32_bf16 v[92:95], a[148:151], v[132:135], v[92:95]
    v_mul_f32 v39, s92, v39
    v_cvt_pk_bf16_f32 v155, v38, v39
    s_waitcnt lgkmcnt(4)
    v_lshlrev_b32 v32, 16, v156
    v_and_b32 v33, 0xffff0000, v156
    v_mul_f32 v32, s92, v32
    v_mul_f32 v33, s92, v33
    v_cvt_pk_bf16_f32 v156, v32, v33
    v_lshlrev_b32 v34, 16, v157
    v_and_b32 v35, 0xffff0000, v157
    v_mul_f32 v34, s92, v34
    v_mul_f32 v35, s92, v35
    v_mfma_f32_16x16x32_bf16 v[92:95], a[152:155], v[136:139], v[92:95]
    v_cvt_pk_bf16_f32 v157, v34, v35
    v_lshlrev_b32 v36, 16, v158
    v_and_b32 v37, 0xffff0000, v158
    v_mul_f32 v36, s92, v36
    v_mul_f32 v37, s92, v37
    v_cvt_pk_bf16_f32 v158, v36, v37
    v_lshlrev_b32 v38, 16, v159
    v_and_b32 v39, 0xffff0000, v159
    v_mul_f32 v38, s92, v38
    v_mfma_f32_16x16x32_bf16 v[92:95], a[156:159], v[140:143], v[92:95]
    v_mul_f32 v39, s92, v39
    v_cvt_pk_bf16_f32 v159, v38, v39
    s_waitcnt vmcnt(14)
    s_barrier
    ds_read_b128 v[176:179], v52
    ds_read_b128 v[180:183], v53
    ds_read_b128 v[184:187], v54
    ds_read_b128 v[188:191], v55
    s_waitcnt lgkmcnt(7)
    v_lshlrev_b32 v32, 16, v160
    v_and_b32 v33, 0xffff0000, v160
    v_mul_f32 v32, s92, v32
    v_mul_f32 v33, s92, v33
    v_cvt_pk_bf16_f32 v160, v32, v33
    v_lshlrev_b32 v34, 16, v161
    v_and_b32 v35, 0xffff0000, v161
    v_mul_f32 v34, s92, v34
    v_mul_f32 v35, s92, v35
    v_mfma_f32_16x16x32_bf16 v[96:99], a[128:131], v[144:147], 0
    v_cvt_pk_bf16_f32 v161, v34, v35
    v_lshlrev_b32 v36, 16, v162
    v_and_b32 v37, 0xffff0000, v162
    v_mul_f32 v36, s92, v36
    v_mul_f32 v37, s92, v37
    v_cvt_pk_bf16_f32 v162, v36, v37
    v_lshlrev_b32 v38, 16, v163
    v_and_b32 v39, 0xffff0000, v163
    v_mul_f32 v38, s92, v38
    v_mfma_f32_16x16x32_bf16 v[96:99], a[132:135], v[148:151], v[96:99]
    v_mul_f32 v39, s92, v39
    v_cvt_pk_bf16_f32 v163, v38, v39
    s_waitcnt lgkmcnt(6)
    v_lshlrev_b32 v32, 16, v164
    v_and_b32 v33, 0xffff0000, v164
    v_mul_f32 v32, s92, v32
    v_mul_f32 v33, s92, v33
    v_cvt_pk_bf16_f32 v164, v32, v33
    v_lshlrev_b32 v34, 16, v165
    v_and_b32 v35, 0xffff0000, v165
    v_mul_f32 v34, s92, v34
    v_mul_f32 v35, s92, v35
    v_mfma_f32_16x16x32_bf16 v[96:99], a[136:139], v[152:155], v[96:99]
    v_cvt_pk_bf16_f32 v165, v34, v35
    v_lshlrev_b32 v36, 16, v166
    v_and_b32 v37, 0xffff0000, v166
    v_mul_f32 v36, s92, v36
    v_mul_f32 v37, s92, v37
    v_cvt_pk_bf16_f32 v166, v36, v37
    v_lshlrev_b32 v38, 16, v167
    v_and_b32 v39, 0xffff0000, v167
    v_mul_f32 v38, s92, v38
    v_mfma_f32_16x16x32_bf16 v[96:99], a[140:143], v[156:159], v[96:99]
    v_mul_f32 v39, s92, v39
    v_cvt_pk_bf16_f32 v167, v38, v39
    s_waitcnt lgkmcnt(5)
    v_lshlrev_b32 v32, 16, v168
    v_and_b32 v33, 0xffff0000, v168
    v_mul_f32 v32, s92, v32
    v_mul_f32 v33, s92, v33
    v_cvt_pk_bf16_f32 v168, v32, v33
    v_lshlrev_b32 v34, 16, v169
    v_and_b32 v35, 0xffff0000, v169
    v_mul_f32 v34, s92, v34
    v_mul_f32 v35, s92, v35
    v_mfma_f32_16x16x32_bf16 v[100:103], a[144:147], v[144:147], 0
    v_cvt_pk_bf16_f32 v169, v34, v35
    v_lshlrev_b32 v36, 16, v170
    v_and_b32 v37, 0xffff0000, v170
    v_mul_f32 v36, s92, v36
    v_mul_f32 v37, s92, v37
    v_cvt_pk_bf16_f32 v170, v36, v37
    v_lshlrev_b32 v38, 16, v171
    v_and_b32 v39, 0xffff0000, v171
    v_mul_f32 v38, s92, v38
    v_mfma_f32_16x16x32_bf16 v[100:103], a[148:151], v[148:151], v[100:103]
    v_mul_f32 v39, s92, v39
    v_cvt_pk_bf16_f32 v171, v38, v39
    s_waitcnt lgkmcnt(4)
    v_lshlrev_b32 v32, 16, v172
    v_and_b32 v33, 0xffff0000, v172
    v_mul_f32 v32, s92, v32
    v_mul_f32 v33, s92, v33
    v_cvt_pk_bf16_f32 v172, v32, v33
    v_lshlrev_b32 v34, 16, v173
    v_and_b32 v35, 0xffff0000, v173
    v_mul_f32 v34, s92, v34
    v_mul_f32 v35, s92, v35
    v_mfma_f32_16x16x32_bf16 v[100:103], a[152:155], v[152:155], v[100:103]
    v_cvt_pk_bf16_f32 v173, v34, v35
    v_lshlrev_b32 v36, 16, v174
    v_and_b32 v37, 0xffff0000, v174
    v_mul_f32 v36, s92, v36
    v_mul_f32 v37, s92, v37
    v_cvt_pk_bf16_f32 v174, v36, v37
    v_lshlrev_b32 v38, 16, v175
    v_and_b32 v39, 0xffff0000, v175
    v_mul_f32 v38, s92, v38
    v_mfma_f32_16x16x32_bf16 v[100:103], a[156:159], v[156:159], v[100:103]
    v_mul_f32 v39, s92, v39
    v_cvt_pk_bf16_f32 v175, v38, v39
    s_cmp_lg_u32 s44, 0
    s_cbranch_scc1 SKIP_ATOM
    v_mov_b32 v5, 1
    v_mov_b32 v6, 0
    s_lshl_b32 s3, s56, 2
    s_mov_b64 exec, 1
    buffer_atomic_add v5, v6, s[84:87], s3 offen offset:128 sc1
    s_mov_b64 exec, -1
SKIP_ATOM:
    s_waitcnt lgkmcnt(0)
    s_barrier
    v_max3_f32 v1, v80, v81, v82
    v_max3_f32 v1, v1, v83, v84
    v_mfma_f32_16x16x32_bf16 v[104:107], a[128:131], v[160:163], 0
    v_max3_f32 v1, v1, v85, v86
    v_max_f32 v1, v1, v87
    ds_read_b64_tr_b16 a[192:193], v20 offset:0
    v_mov_b32 v2, v1
    s_nop 1
    v_mfma_f32_16x16x32_bf16 v[104:107], a[132:135], v[164:167], v[104:107]
    v_permlane32_swap_b32 v1, v2
    v_max_f32 v1, v1, v2
    ds_read_b64_tr_b16 a[194:195], v20 offset:4096
    v_mov_b32 v2, v1
    s_nop 1
    v_mfma_f32_16x16x32_bf16 v[104:107], a[136:139], v[168:171], v[104:107]
    v_permlane16_swap_b32 v1, v2
    v_max_f32 v1, v1, v2
    ds_read_b64_tr_b16 a[196:197], v21 offset:0
    v_ceil_f32 v1, v1
    v_add_f32 v1, 0x41000000, v1
    v_mfma_f32_16x16x32_bf16 v[104:107], a[140:143], v[172:175], v[104:107]
    v_sub_f32 v80, v80, v1
    v_sub_f32 v81, v81, v1
    ds_read_b64_tr_b16 a[198:199], v21 offset:4096
    v_sub_f32 v82, v82, v1
    v_sub_f32 v83, v83, v1
    v_mfma_f32_16x16x32_bf16 v[108:111], a[144:147], v[160:163], 0
    v_sub_f32 v84, v84, v1
    v_sub_f32 v85, v85, v1
    ds_read_b64_tr_b16 a[200:201], v22 offset:0
    v_sub_f32 v86, v86, v1
    v_sub_f32 v87, v87, v1
    v_mfma_f32_16x16x32_bf16 v[108:111], a[148:151], v[164:167], v[108:111]
    v_sub_f32 v64, 0, v1
    v_sub_f32 v65, 0, v1
    ds_read_b64_tr_b16 a[202:203], v22 offset:4096
    v_sub_f32 v66, 0, v1
    v_sub_f32 v67, 0, v1
    v_mfma_f32_16x16x32_bf16 v[108:111], a[152:155], v[168:171], v[108:111]
    v_max3_f32 v3, v88, v89, v90
    v_max3_f32 v3, v3, v91, v92
    ds_read_b64_tr_b16 a[204:205], v23 offset:0
    v_max3_f32 v3, v3, v93, v94
    v_max_f32 v3, v3, v95
    v_mfma_f32_16x16x32_bf16 v[108:111], a[156:159], v[172:175], v[108:111]
    v_mov_b32 v4, v3
    s_nop 1
    ds_read_b64_tr_b16 a[206:207], v23 offset:4096
    v_permlane32_swap_b32 v3, v4
    v_max_f32 v3, v3, v4
    ds_read_b64_tr_b16 a[208:209], v24 offset:0
    v_mov_b32 v4, v3
    s_nop 1
    ds_read_b64_tr_b16 a[210:211], v24 offset:4096
    v_permlane16_swap_b32 v3, v4
    v_max_f32 v3, v3, v4
    ds_read_b64_tr_b16 a[212:213], v25 offset:0
    v_ceil_f32 v3, v3
    v_add_f32 v3, 0x41000000, v3
    ds_read_b64_tr_b16 a[214:215], v25 offset:4096
    v_sub_f32 v88, v88, v3
    v_sub_f32 v89, v89, v3
    ds_read_b64_tr_b16 a[216:217], v26 offset:0
    v_sub_f32 v90, v90, v3
    v_sub_f32 v91, v91, v3
    ds_read_b64_tr_b16 a[218:219], v26 offset:4096
    v_sub_f32 v92, v92, v3
    v_sub_f32 v93, v93, v3
    ds_read_b64_tr_b16 a[220:221], v27 offset:0
    v_sub_f32 v94, v94, v3
    v_sub_f32 v95, v95, v3
    ds_read_b64_tr_b16 a[222:223], v27 offset:4096
    v_sub_f32 v68, 0, v3
    v_sub_f32 v69, 0, v3
    s_mov_b32 s54, s47
    v_sub_f32 v70, 0, v3
    v_sub_f32 v71, 0, v3
    s_add_u32 s46, s46, 8192
    v_exp_f32 v32, v80
    v_exp_f32 v33, v81
    s_and_b32 s46, s46, 0x3ffff
    v_exp_f32 v34, v82
    v_cvt_pk_bf16_f32 v48, v32, v33
    s_cmp_lt_u32 s55, 32
    v_exp_f32 v35, v83
    v_exp_f32 v36, v84
    s_cselect_b32 s47, s46, 0x40000
    v_cvt_pk_bf16_f32 v49, v34, v35
    v_exp_f32 v37, v85
    s_add_u32 m0, s27, 0
    v_exp_f32 v38, v86
    v_cvt_pk_bf16_f32 v50, v36, v37
    s_add_u32 s55, s55, 1
    v_exp_f32 v39, v87
    v_exp_f32 v32, v88
    buffer_load_dwordx4 v28, s[28:31], s47 offen nt lds
    v_cvt_pk_bf16_f32 v51, v38, v39
    v_exp_f32 v33, v89
    buffer_load_dwordx4 v29, s[28:31], s47 offen offset:1024 nt lds
    v_exp_f32 v34, v90
    v_cvt_pk_bf16_f32 v52, v32, v33
    s_add_u32 m0, s26, 90112
    v_exp_f32 v35, v91
    v_exp_f32 v36, v92
    s_nop 0
    v_cvt_pk_bf16_f32 v53, v34, v35
    v_exp_f32 v37, v93
    buffer_load_dwordx4 v30, s[32:35], s54 offen nt lds
    v_exp_f32 v38, v94
    v_cvt_pk_bf16_f32 v54, v36, v37
    buffer_load_dwordx4 v31, s[32:35], s54 offen offset:1024 nt lds
    v_exp_f32 v39, v95
    s_nop 0
    ds_read_b128 a[160:163], v16 offset:8192
    v_cvt_pk_bf16_f32 v55, v38, v39
    ds_read_b128 a[164:167], v17 offset:8192
    ds_read_b128 a[168:171], v18 offset:8192
    ds_read_b128 a[172:175], v19 offset:8192
    ds_read_b128 a[176:179], v16 offset:12288
    ds_read_b128 a[180:183], v17 offset:12288
    ds_read_b128 a[184:187], v18 offset:12288
    ds_read_b128 a[188:191], v19 offset:12288
    s_waitcnt lgkmcnt(8)
    v_max3_f32 v1, v96, v97, v98
    v_max3_f32 v1, v1, v99, v100
    v_max3_f32 v1, v1, v101, v102
    v_max_f32 v1, v1, v103
    v_mfma_f32_16x16x32_bf16 a[0:3], a[192:195], v[48:51], 0
    v_mov_b32 v2, v1
    s_nop 1
    v_permlane32_swap_b32 v1, v2
    v_max_f32 v1, v1, v2
    v_mfma_f32_16x16x32_bf16 a[32:35], a[192:195], v[52:55], 0
    v_mov_b32 v2, v1
    s_nop 1
    v_permlane16_swap_b32 v1, v2
    v_max_f32 v1, v1, v2
    v_mfma_f32_16x16x32_bf16 a[4:7], a[196:199], v[48:51], 0
    v_ceil_f32 v1, v1
    v_add_f32 v1, 0x41000000, v1
    v_sub_f32 v96, v96, v1
    v_sub_f32 v97, v97, v1
    v_mfma_f32_16x16x32_bf16 a[36:39], a[196:199], v[52:55], 0
    v_sub_f32 v98, v98, v1
    v_sub_f32 v99, v99, v1
    v_sub_f32 v100, v100, v1
    v_sub_f32 v101, v101, v1
    v_mfma_f32_16x16x32_bf16 a[8:11], a[200:203], v[48:51], 0
    v_sub_f32 v102, v102, v1
    v_sub_f32 v103, v103, v1
    v_sub_f32 v72, 0, v1
    v_sub_f32 v73, 0, v1
    v_mfma_f32_16x16x32_bf16 a[40:43], a[200:203], v[52:55], 0
    v_sub_f32 v74, 0, v1
    v_sub_f32 v75, 0, v1
    v_max3_f32 v3, v104, v105, v106
    v_max3_f32 v3, v3, v107, v108
    v_mfma_f32_16x16x32_bf16 a[12:15], a[204:207], v[48:51], 0
    v_max3_f32 v3, v3, v109, v110
    v_max_f32 v3, v3, v111
    v_mov_b32 v4, v3
    s_nop 1
    v_mfma_f32_16x16x32_bf16 a[44:47], a[204:207], v[52:55], 0
    v_permlane32_swap_b32 v3, v4
    v_max_f32 v3, v3, v4
    v_mov_b32 v4, v3
    s_nop 1
    v_mfma_f32_16x16x32_bf16 a[16:19], a[208:211], v[48:51], 0
    v_permlane16_swap_b32 v3, v4
    v_max_f32 v3, v3, v4
    v_ceil_f32 v3, v3
    v_add_f32 v3, 0x41000000, v3
    v_mfma_f32_16x16x32_bf16 a[48:51], a[208:211], v[52:55], 0
    v_sub_f32 v104, v104, v3
    v_sub_f32 v105, v105, v3
    v_sub_f32 v106, v106, v3
    v_sub_f32 v107, v107, v3
    v_mfma_f32_16x16x32_bf16 a[20:23], a[212:215], v[48:51], 0
    v_sub_f32 v108, v108, v3
    v_sub_f32 v109, v109, v3
    v_sub_f32 v110, v110, v3
    v_sub_f32 v111, v111, v3
    v_mfma_f32_16x16x32_bf16 a[52:55], a[212:215], v[52:55], 0
    v_sub_f32 v76, 0, v3
    v_sub_f32 v77, 0, v3
    v_sub_f32 v78, 0, v3
    v_mfma_f32_16x16x32_bf16 a[24:27], a[216:219], v[48:51], 0
    v_mfma_f32_16x16x32_bf16 a[56:59], a[216:219], v[52:55], 0
    v_mfma_f32_16x16x32_bf16 a[28:31], a[220:223], v[48:51], 0
    v_mfma_f32_16x16x32_bf16 a[60:63], a[220:223], v[52:55], 0
    v_mfma_f32_16x16x32_bf16 v[196:199], v[8:11], v[48:51], 0
    v_mfma_f32_16x16x32_bf16 v[200:203], v[8:11], v[52:55], 0
    s_waitcnt vmcnt(14) lgkmcnt(0)
    v_mfma_f32_16x16x32_bf16 v[80:83], a[160:163], v[112:115], v[64:67]
    s_barrier
    v_sub_f32 v79, 0, v3
    v_exp_f32 v32, v96
    v_mfma_f32_16x16x32_bf16 v[80:83], a[164:167], v[116:119], v[80:83]
    s_mov_b32 s54, s47
    v_exp_f32 v33, v97
    v_exp_f32 v34, v98
    v_mfma_f32_16x16x32_bf16 v[80:83], a[168:171], v[120:123], v[80:83]
    s_add_u32 s46, s46, 8192
    v_cvt_pk_bf16_f32 v56, v32, v33
    v_exp_f32 v35, v99
    v_mfma_f32_16x16x32_bf16 v[80:83], a[172:175], v[124:127], v[80:83]
    s_and_b32 s46, s46, 0x3ffff
    v_exp_f32 v36, v100
    v_cvt_pk_bf16_f32 v57, v34, v35
    v_mfma_f32_16x16x32_bf16 v[84:87], a[176:179], v[112:115], v[64:67]
    s_cmp_lt_u32 s55, 32
    v_exp_f32 v37, v101
    v_exp_f32 v38, v102
    v_mfma_f32_16x16x32_bf16 v[84:87], a[180:183], v[116:119], v[84:87]
    s_cselect_b32 s47, s46, 0x40000
    v_cvt_pk_bf16_f32 v58, v36, v37
    v_exp_f32 v39, v103
    v_mfma_f32_16x16x32_bf16 v[84:87], a[184:187], v[120:123], v[84:87]
    s_add_u32 s55, s55, 1
    v_exp_f32 v32, v104
    v_cvt_pk_bf16_f32 v59, v38, v39
    v_mfma_f32_16x16x32_bf16 v[84:87], a[188:191], v[124:127], v[84:87]
    s_add_u32 m0, s27, 8192
    v_exp_f32 v33, v105
    v_exp_f32 v34, v106
    v_mfma_f32_16x16x32_bf16 v[88:91], a[160:163], v[128:131], v[68:71]
    v_cvt_pk_bf16_f32 v60, v32, v33
    v_exp_f32 v35, v107
    v_mfma_f32_16x16x32_bf16 v[88:91], a[164:167], v[132:135], v[88:91]
    v_exp_f32 v36, v108
    v_cvt_pk_bf16_f32 v61, v34, v35
    v_mfma_f32_16x16x32_bf16 v[88:91], a[168:171], v[136:139], v[88:91]
    v_exp_f32 v37, v109
    v_exp_f32 v38, v110
    v_mfma_f32_16x16x32_bf16 v[88:91], a[172:175], v[140:143], v[88:91]
    v_cvt_pk_bf16_f32 v62, v36, v37
    v_exp_f32 v39, v111
    v_mfma_f32_16x16x32_bf16 v[92:95], a[176:179], v[128:131], v[68:71]
    ds_read_b64_tr_b16 a[224:225], v20 offset:8192
    s_nop 0
    v_cvt_pk_bf16_f32 v63, v38, v39
    v_mfma_f32_16x16x32_bf16 v[92:95], a[180:183], v[132:135], v[92:95]
    ds_read_b64_tr_b16 a[226:227], v20 offset:12288
    v_mfma_f32_16x16x32_bf16 v[92:95], a[184:187], v[136:139], v[92:95]
    ds_read_b64_tr_b16 a[228:229], v21 offset:8192
    v_exp_f32 v32, v80
    v_mfma_f32_16x16x32_bf16 v[92:95], a[188:191], v[140:143], v[92:95]
    ds_read_b64_tr_b16 a[230:231], v21 offset:12288
    v_exp_f32 v33, v81
    v_mfma_f32_16x16x32_bf16 a[64:67], a[192:195], v[56:59], 0
    ds_read_b64_tr_b16 a[232:233], v22 offset:8192
    v_mfma_f32_16x16x32_bf16 a[96:99], a[192:195], v[60:63], 0
    ds_read_b64_tr_b16 a[234:235], v22 offset:12288
    v_mfma_f32_16x16x32_bf16 a[68:71], a[196:199], v[56:59], 0
    buffer_load_dwordx4 v28, s[28:31], s47 offen nt lds
    v_exp_f32 v34, v82
    v_mfma_f32_16x16x32_bf16 a[100:103], a[196:199], v[60:63], 0
    ds_read_b64_tr_b16 a[236:237], v23 offset:8192
    v_exp_f32 v35, v83
    v_mfma_f32_16x16x32_bf16 a[72:75], a[200:203], v[56:59], 0
    ds_read_b64_tr_b16 a[238:239], v23 offset:12288
    v_cvt_pk_bf16_f32 v48, v32, v33
    v_mfma_f32_16x16x32_bf16 a[104:107], a[200:203], v[60:63], 0
    ds_read_b64_tr_b16 a[240:241], v24 offset:8192
    v_mfma_f32_16x16x32_bf16 a[76:79], a[204:207], v[56:59], 0
    v_exp_f32 v36, v84
    v_mfma_f32_16x16x32_bf16 a[108:111], a[204:207], v[60:63], 0
    v_exp_f32 v37, v85
    v_mfma_f32_16x16x32_bf16 a[80:83], a[208:211], v[56:59], 0
    ds_read_b64_tr_b16 a[242:243], v24 offset:12288
    v_cvt_pk_bf16_f32 v49, v34, v35
    v_mfma_f32_16x16x32_bf16 a[112:115], a[208:211], v[60:63], 0
    buffer_load_dwordx4 v29, s[28:31], s47 offen offset:1024 nt lds
    v_mfma_f32_16x16x32_bf16 a[84:87], a[212:215], v[56:59], 0
    s_add_u32 m0, s27, 65536
    v_exp_f32 v38, v86
    v_mfma_f32_16x16x32_bf16 a[116:119], a[212:215], v[60:63], 0
    v_exp_f32 v39, v87
    v_mfma_f32_16x16x32_bf16 a[88:91], a[216:219], v[56:59], 0
    ds_read_b64_tr_b16 a[244:245], v25 offset:8192
    v_cvt_pk_bf16_f32 v50, v36, v37
    v_mfma_f32_16x16x32_bf16 a[120:123], a[216:219], v[60:63], 0
    ds_read_b64_tr_b16 a[246:247], v25 offset:12288
    v_or3_b32 v12, v48, v49, v50
    v_mfma_f32_16x16x32_bf16 a[92:95], a[220:223], v[56:59], 0
    v_exp_f32 v32, v88
    v_mfma_f32_16x16x32_bf16 a[124:127], a[220:223], v[60:63], 0
    v_exp_f32 v33, v89
    v_mfma_f32_16x16x32_bf16 v[204:207], v[8:11], v[56:59], 0
    ds_read_b64_tr_b16 a[248:249], v26 offset:8192
    v_cvt_pk_bf16_f32 v51, v38, v39
    v_mfma_f32_16x16x32_bf16 v[208:211], v[8:11], v[60:63], 0
    ds_read_b64_tr_b16 a[250:251], v26 offset:12288
    v_mfma_f32_16x16x32_bf16 v[96:99], a[160:163], v[144:147], v[72:75]
    v_exp_f32 v34, v90
    v_mfma_f32_16x16x32_bf16 v[96:99], a[164:167], v[148:151], v[96:99]
    v_exp_f32 v35, v91
    v_mfma_f32_16x16x32_bf16 v[96:99], a[168:171], v[152:155], v[96:99]
    ds_read_b64_tr_b16 a[252:253], v27 offset:8192
    v_cvt_pk_bf16_f32 v52, v32, v33
    v_mfma_f32_16x16x32_bf16 v[96:99], a[172:175], v[156:159], v[96:99]
    ds_read_b64_tr_b16 a[254:255], v27 offset:12288
    v_or3_b32 v12, v12, v51, v52
    v_mfma_f32_16x16x32_bf16 v[100:103], a[176:179], v[144:147], v[72:75]
    v_exp_f32 v36, v92
    v_mfma_f32_16x16x32_bf16 v[100:103], a[180:183], v[148:151], v[100:103]
    v_exp_f32 v37, v93
    v_mfma_f32_16x16x32_bf16 v[100:103], a[184:187], v[152:155], v[100:103]
    ds_read_b128 a[128:131], v16 offset:16384
    v_cvt_pk_bf16_f32 v53, v34, v35
    v_mfma_f32_16x16x32_bf16 v[100:103], a[188:191], v[156:159], v[100:103]
    ds_read_b128 a[132:135], v17 offset:16384
    v_mfma_f32_16x16x32_bf16 v[104:107], a[160:163], v[160:163], v[76:79]
    v_exp_f32 v38, v94
    v_mfma_f32_16x16x32_bf16 v[104:107], a[164:167], v[164:167], v[104:107]
    v_exp_f32 v39, v95
    v_mfma_f32_16x16x32_bf16 v[104:107], a[168:171], v[168:171], v[104:107]
    buffer_load_dwordx4 v30, s[32:35], s54 offen nt lds
    v_cvt_pk_bf16_f32 v54, v36, v37
    v_mfma_f32_16x16x32_bf16 v[104:107], a[172:175], v[172:175], v[104:107]
    v_or3_b32 v12, v12, v53, v54
    v_cvt_pk_bf16_f32 v55, v38, v39
    v_mfma_f32_16x16x32_bf16 v[108:111], a[176:179], v[160:163], v[76:79]
    v_bitop3_b32 v12, v12, v55, s48 bitop3:0xa8
    v_cmp_ne_u32 vcc, 0, v12
    v_mfma_f32_16x16x32_bf16 v[108:111], a[180:183], v[164:167], v[108:111]
    ds_read_b128 a[136:139], v18 offset:16384
    v_mfma_f32_16x16x32_bf16 v[108:111], a[184:187], v[168:171], v[108:111]
    s_waitcnt lgkmcnt(3)
    v_exp_f32 v32, v96
    v_mfma_f32_16x16x32_bf16 v[108:111], a[188:191], v[172:175], v[108:111]
    s_cbranch_vccnz STUB_Ap1
BACK_Ap1:
    v_exp_f32 v33, v97
    v_mfma_f32_16x16x32_bf16 a[0:3], a[224:227], v[48:51], a[0:3]
    ds_read_b128 a[140:143], v19 offset:16384
    v_mfma_f32_16x16x32_bf16 a[32:35], a[224:227], v[52:55], a[32:35]
    buffer_load_dwordx4 v31, s[32:35], s54 offen offset:1024 nt lds
    v_mfma_f32_16x16x32_bf16 a[4:7], a[228:231], v[48:51], a[4:7]
    v_exp_f32 v34, v98
    v_mfma_f32_16x16x32_bf16 a[36:39], a[228:231], v[52:55], a[36:39]
    v_exp_f32 v35, v99
    v_mfma_f32_16x16x32_bf16 a[8:11], a[232:235], v[48:51], a[8:11]
    ds_read_b128 a[144:147], v16 offset:20480
    v_cvt_pk_bf16_f32 v56, v32, v33
    v_mfma_f32_16x16x32_bf16 a[40:43], a[232:235], v[52:55], a[40:43]
    ds_read_b128 a[148:151], v17 offset:20480
    v_mfma_f32_16x16x32_bf16 a[12:15], a[236:239], v[48:51], a[12:15]
    v_exp_f32 v36, v100
    v_mfma_f32_16x16x32_bf16 a[44:47], a[236:239], v[52:55], a[44:47]
    v_exp_f32 v37, v101
    v_mfma_f32_16x16x32_bf16 a[16:19], a[240:243], v[48:51], a[16:19]
    ds_read_b128 a[152:155], v18 offset:20480
    v_cvt_pk_bf16_f32 v57, v34, v35
    v_mfma_f32_16x16x32_bf16 a[48:51], a[240:243], v[52:55], a[48:51]
    ds_read_b128 a[156:159], v19 offset:20480
    v_mfma_f32_16x16x32_bf16 a[20:23], a[244:247], v[48:51], a[20:23]
    v_exp_f32 v38, v102
    v_mfma_f32_16x16x32_bf16 a[52:55], a[244:247], v[52:55], a[52:55]
    v_exp_f32 v39, v103
    v_mfma_f32_16x16x32_bf16 a[24:27], a[248:251], v[48:51], a[24:27]
    v_cvt_pk_bf16_f32 v58, v36, v37
    v_mfma_f32_16x16x32_bf16 a[56:59], a[248:251], v[52:55], a[56:59]
    v_or3_b32 v13, v56, v57, v58
    v_mfma_f32_16x16x32_bf16 a[28:31], a[252:255], v[48:51], a[28:31]
    v_exp_f32 v32, v104
    v_mfma_f32_16x16x32_bf16 a[60:63], a[252:255], v[52:55], a[60:63]
    v_exp_f32 v33, v105
    v_mfma_f32_16x16x32_bf16 v[196:199], v[8:11], v[48:51], v[196:199]
    v_cvt_pk_bf16_f32 v59, v38, v39
    v_mfma_f32_16x16x32_bf16 v[200:203], v[8:11], v[52:55], v[200:203]
    s_waitcnt vmcnt(8) lgkmcnt(0)
    s_barrier
    v_and_b32 v1, 0x1fff, v16
    v_add_u32 v1, 0x22000, v1
    v_and_b32 v2, 0x1fff, v17
    v_add_u32 v2, 0x22000, v2
    v_and_b32 v3, 0x1fff, v18
    v_add_u32 v3, 0x22000, v3
    v_and_b32 v4, 0x1fff, v19
    v_add_u32 v4, 0x22000, v4
    ds_read_b128 v[224:227], v1 offset:0
    ds_read_b128 v[228:231], v2 offset:0
    ds_read_b128 v[232:235], v3 offset:0
    ds_read_b128 v[236:239], v4 offset:0
    ds_read_b128 v[240:243], v1 offset:4096
    ds_read_b128 v[244:247], v2 offset:4096
    ds_read_b128 v[248:251], v3 offset:4096
    ds_read_b128 v[252:255], v4 offset:4096
    s_lshl_b32 s3, s95, 7
    v_and_b32 v1, 0x1fff, v20
    v_xor_b32 v1, s3, v1
    v_add_u32 v1, 0x20000, v1
    v_and_b32 v2, 0x1fff, v21
    v_xor_b32 v2, s3, v2
    v_add_u32 v2, 0x20000, v2
    v_and_b32 v3, 0x1fff, v22
    v_xor_b32 v3, s3, v3
    v_add_u32 v3, 0x20000, v3
    v_and_b32 v4, 0x1fff, v23
    v_xor_b32 v4, s3, v4
    v_add_u32 v4, 0x20000, v4
    s_mov_b32 s4, 0x4eabfb8f
    v_mov_b32 v6, 0xceabfb8f
    s_waitcnt lgkmcnt(0)
    v_mfma_f32_16x16x32_bf16 v[212:215], v[224:227], v[176:179], 0
    v_mfma_f32_16x16x32_bf16 v[212:215], v[228:231], v[180:183], v[212:215]
    v_mfma_f32_16x16x32_bf16 v[212:215], v[232:235], v[184:187], v[212:215]
    v_mfma_f32_16x16x32_bf16 v[212:215], v[236:239], v[188:191], v[212:215]
    v_mfma_f32_16x16x32_bf16 v[216:219], v[240:243], v[176:179], 0
    v_mfma_f32_16x16x32_bf16 v[216:219], v[244:247], v[180:183], v[216:219]
    v_mfma_f32_16x16x32_bf16 v[216:219], v[248:251], v[184:187], v[216:219]
    v_mfma_f32_16x16x32_bf16 v[216:219], v[252:255], v[188:191], v[216:219]
    s_nop 3
    ds_read_b64_tr_b16 v[232:233], v1 offset:0
    ds_read_b64_tr_b16 v[234:235], v1 offset:4096
    ds_read_b64_tr_b16 v[236:237], v2 offset:0
    ds_read_b64_tr_b16 v[238:239], v2 offset:4096
    ds_read_b64_tr_b16 v[240:241], v3 offset:0
    ds_read_b64_tr_b16 v[242:243], v3 offset:4096
    ds_read_b64_tr_b16 v[244:245], v4 offset:0
    ds_read_b64_tr_b16 v[246:247], v4 offset:4096
    v_lshlrev_b32 v224, 16, v40
    v_fma_f32 v224, v224, s4, v6
    v_and_b32 v225, 0xffff0000, v40
    v_fma_f32 v225, v225, s4, v6
    v_lshlrev_b32 v226, 16, v41
    v_fma_f32 v226, v226, s4, v6
    v_and_b32 v227, 0xffff0000, v41
    v_fma_f32 v227, v227, s4, v6
    v_lshlrev_b32 v228, 16, v42
    v_fma_f32 v228, v228, s4, v6
    v_and_b32 v229, 0xffff0000, v42
    v_fma_f32 v229, v229, s4, v6
    v_lshlrev_b32 v230, 16, v43
    v_fma_f32 v230, v230, s4, v6
    v_and_b32 v231, 0xffff0000, v43
    v_fma_f32 v231, v231, s4, v6
    v_fma_f32 v212, v212, s92, v224
    v_fma_f32 v213, v213, s92, v225
    v_fma_f32 v214, v214, s92, v226
    v_fma_f32 v215, v215, s92, v227
    v_fma_f32 v216, v216, s92, v228
    v_fma_f32 v217, v217, s92, v229
    v_fma_f32 v218, v218, s92, v230
    v_fma_f32 v219, v219, s92, v231
    v_max3_f32 v192, v212, v213, v214
    v_max3_f32 v192, v192, v215, v216
    v_max3_f32 v192, v192, v217, v218
    v_max_f32 v192, v192, v219
    v_mov_b32 v193, v192
    s_nop 1
    v_permlane32_swap_b32 v192, v193
    v_max_f32 v192, v192, v193
    v_mov_b32 v193, v192
    s_nop 1
    v_permlane16_swap_b32 v192, v193
    v_max_f32 v192, v192, v193
    v_ceil_f32 v192, v192
    v_sub_f32 v212, v212, v192
    v_exp_f32 v212, v212
    v_sub_f32 v213, v213, v192
    v_exp_f32 v213, v213
    v_sub_f32 v214, v214, v192
    v_exp_f32 v214, v214
    v_sub_f32 v215, v215, v192
    v_exp_f32 v215, v215
    v_sub_f32 v216, v216, v192
    v_exp_f32 v216, v216
    v_sub_f32 v217, v217, v192
    v_exp_f32 v217, v217
    v_sub_f32 v218, v218, v192
    v_exp_f32 v218, v218
    v_sub_f32 v219, v219, v192
    v_exp_f32 v219, v219
    v_add_f32 v193, v212, v213
    v_add_f32 v193, v193, v214
    v_add_f32 v193, v193, v215
    v_add_f32 v193, v193, v216
    v_add_f32 v193, v193, v217
    v_add_f32 v193, v193, v218
    v_add_f32 v193, v193, v219
    v_mov_b32 v5, v193
    s_nop 1
    v_permlane32_swap_b32 v193, v5
    v_add_f32 v193, v193, v5
    v_mov_b32 v5, v193
    s_nop 1
    v_permlane16_swap_b32 v193, v5
    v_add_f32 v193, v193, v5
    v_cvt_pk_bf16_f32 v248, v212, v213
    v_cvt_pk_bf16_f32 v249, v214, v215
    v_cvt_pk_bf16_f32 v250, v216, v217
    v_cvt_pk_bf16_f32 v251, v218, v219
    s_waitcnt lgkmcnt(0)
    s_nop 0
    v_mfma_f32_16x16x32_bf16 v[176:179], v[232:235], v[248:251], 0
    v_mfma_f32_16x16x32_bf16 v[180:183], v[236:239], v[248:251], 0
    v_mfma_f32_16x16x32_bf16 v[184:187], v[240:243], v[248:251], 0
    v_mfma_f32_16x16x32_bf16 v[188:191], v[244:247], v[248:251], 0
    s_branch LOOP_P2
LOOP:
    v_mfma_f32_16x16x32_bf16 v[80:83], a[128:131], v[112:115], v[64:67]
    s_barrier
    v_exp_f32 v34, v106
    v_mfma_f32_16x16x32_bf16 v[80:83], a[132:135], v[116:119], v[80:83]
    s_mov_b32 s54, s47
    v_exp_f32 v35, v107
    v_mfma_f32_16x16x32_bf16 v[80:83], a[136:139], v[120:123], v[80:83]
    s_add_u32 s46, s46, 8192
    ds_read_b64_tr_b16 a[192:193], v20 offset:0
    v_cvt_pk_bf16_f32 v60, v32, v33
    v_mfma_f32_16x16x32_bf16 v[80:83], a[140:143], v[124:127], v[80:83]
    s_and_b32 s46, s46, 0x3ffff
    ds_read_b64_tr_b16 a[194:195], v20 offset:4096
    v_or3_b32 v13, v13, v59, v60
    v_mfma_f32_16x16x32_bf16 v[84:87], a[144:147], v[112:115], v[64:67]
    s_cmp_lt_u32 s55, 32
    v_exp_f32 v36, v108
    v_mfma_f32_16x16x32_bf16 v[84:87], a[148:151], v[116:119], v[84:87]
    s_cselect_b32 s47, s46, 0x40000
    v_exp_f32 v37, v109
    v_mfma_f32_16x16x32_bf16 v[84:87], a[152:155], v[120:123], v[84:87]
    s_add_u32 s55, s55, 1
    ds_read_b64_tr_b16 a[196:197], v21 offset:0
    v_cvt_pk_bf16_f32 v61, v34, v35
    v_mfma_f32_16x16x32_bf16 v[84:87], a[156:159], v[124:127], v[84:87]
    s_add_u32 m0, s27, 0
    ds_read_b64_tr_b16 a[198:199], v21 offset:4096
    v_mfma_f32_16x16x32_bf16 v[88:91], a[128:131], v[128:131], v[68:71]
    v_exp_f32 v38, v110
    v_mfma_f32_16x16x32_bf16 v[88:91], a[132:135], v[132:135], v[88:91]
    v_exp_f32 v39, v111
    v_mfma_f32_16x16x32_bf16 v[88:91], a[136:139], v[136:139], v[88:91]
    ds_read_b64_tr_b16 a[200:201], v22 offset:0
    v_cvt_pk_bf16_f32 v62, v36, v37
    v_mfma_f32_16x16x32_bf16 v[88:91], a[140:143], v[140:143], v[88:91]
    v_or3_b32 v13, v13, v61, v62
    v_cvt_pk_bf16_f32 v63, v38, v39
    v_mfma_f32_16x16x32_bf16 v[92:95], a[144:147], v[128:131], v[68:71]
    v_bitop3_b32 v13, v13, v63, s48 bitop3:0xa8
    v_cmp_ne_u32 vcc, 0, v13
    v_mfma_f32_16x16x32_bf16 v[92:95], a[148:151], v[132:135], v[92:95]
    ds_read_b64_tr_b16 a[202:203], v22 offset:4096
    v_mfma_f32_16x16x32_bf16 v[92:95], a[152:155], v[136:139], v[92:95]
    v_exp_f32 v32, v80
    v_mfma_f32_16x16x32_bf16 v[92:95], a[156:159], v[140:143], v[92:95]
    s_cbranch_vccnz STUB_Bl0
BACK_Bl0:
    v_exp_f32 v33, v81
    v_mfma_f32_16x16x32_bf16 a[64:67], a[224:227], v[56:59], a[64:67]
    buffer_load_dwordx4 v28, s[28:31], s47 offen nt lds
    v_mfma_f32_16x16x32_bf16 a[96:99], a[224:227], v[60:63], a[96:99]
    ds_read_b64_tr_b16 a[204:205], v23 offset:0
    v_mfma_f32_16x16x32_bf16 a[68:71], a[228:231], v[56:59], a[68:71]
    v_exp_f32 v34, v82
    v_mfma_f32_16x16x32_bf16 a[100:103], a[228:231], v[60:63], a[100:103]
    v_exp_f32 v35, v83
    v_mfma_f32_16x16x32_bf16 a[72:75], a[232:235], v[56:59], a[72:75]
    ds_read_b64_tr_b16 a[206:207], v23 offset:4096
    v_cvt_pk_bf16_f32 v48, v32, v33
    v_mfma_f32_16x16x32_bf16 a[104:107], a[232:235], v[60:63], a[104:107]
    ds_read_b64_tr_b16 a[208:209], v24 offset:0
    v_mfma_f32_16x16x32_bf16 a[76:79], a[236:239], v[56:59], a[76:79]
    v_exp_f32 v36, v84
    v_mfma_f32_16x16x32_bf16 a[108:111], a[236:239], v[60:63], a[108:111]
    v_exp_f32 v37, v85
    v_mfma_f32_16x16x32_bf16 a[80:83], a[240:243], v[56:59], a[80:83]
    ds_read_b64_tr_b16 a[210:211], v24 offset:4096
    v_cvt_pk_bf16_f32 v49, v34, v35
    v_mfma_f32_16x16x32_bf16 a[112:115], a[240:243], v[60:63], a[112:115]
    buffer_load_dwordx4 v29, s[28:31], s47 offen offset:1024 nt lds
    v_mfma_f32_16x16x32_bf16 a[84:87], a[244:247], v[56:59], a[84:87]
    s_add_u32 m0, s26, 90112
    v_exp_f32 v38, v86
    v_mfma_f32_16x16x32_bf16 a[116:119], a[244:247], v[60:63], a[116:119]
    v_exp_f32 v39, v87
    v_mfma_f32_16x16x32_bf16 a[88:91], a[248:251], v[56:59], a[88:91]
    ds_read_b64_tr_b16 a[212:213], v25 offset:0
    v_cvt_pk_bf16_f32 v50, v36, v37
    v_mfma_f32_16x16x32_bf16 a[120:123], a[248:251], v[60:63], a[120:123]
    ds_read_b64_tr_b16 a[214:215], v25 offset:4096
    v_or3_b32 v12, v48, v49, v50
    v_mfma_f32_16x16x32_bf16 a[92:95], a[252:255], v[56:59], a[92:95]
    v_exp_f32 v32, v88
    v_mfma_f32_16x16x32_bf16 a[124:127], a[252:255], v[60:63], a[124:127]
    v_exp_f32 v33, v89
    v_mfma_f32_16x16x32_bf16 v[204:207], v[8:11], v[56:59], v[204:207]
    ds_read_b64_tr_b16 a[216:217], v26 offset:0
    v_cvt_pk_bf16_f32 v51, v38, v39
    v_mfma_f32_16x16x32_bf16 v[208:211], v[8:11], v[60:63], v[208:211]
    ds_read_b64_tr_b16 a[218:219], v26 offset:4096
    v_mfma_f32_16x16x32_bf16 v[96:99], a[128:131], v[144:147], v[72:75]
    v_exp_f32 v34, v90
    v_mfma_f32_16x16x32_bf16 v[96:99], a[132:135], v[148:151], v[96:99]
    v_exp_f32 v35, v91
    v_mfma_f32_16x16x32_bf16 v[96:99], a[136:139], v[152:155], v[96:99]
    ds_read_b64_tr_b16 a[220:221], v27 offset:0
    v_cvt_pk_bf16_f32 v52, v32, v33
    v_mfma_f32_16x16x32_bf16 v[96:99], a[140:143], v[156:159], v[96:99]
    ds_read_b64_tr_b16 a[222:223], v27 offset:4096
    v_or3_b32 v12, v12, v51, v52
    v_mfma_f32_16x16x32_bf16 v[100:103], a[144:147], v[144:147], v[72:75]
    v_exp_f32 v36, v92
    v_mfma_f32_16x16x32_bf16 v[100:103], a[148:151], v[148:151], v[100:103]
    v_exp_f32 v37, v93
    v_mfma_f32_16x16x32_bf16 v[100:103], a[152:155], v[152:155], v[100:103]
    ds_read_b128 a[160:163], v16 offset:8192
    v_cvt_pk_bf16_f32 v53, v34, v35
    v_mfma_f32_16x16x32_bf16 v[100:103], a[156:159], v[156:159], v[100:103]
    ds_read_b128 a[164:167], v17 offset:8192
    v_mfma_f32_16x16x32_bf16 v[104:107], a[128:131], v[160:163], v[76:79]
    v_exp_f32 v38, v94
    v_mfma_f32_16x16x32_bf16 v[104:107], a[132:135], v[164:167], v[104:107]
    v_exp_f32 v39, v95
    v_mfma_f32_16x16x32_bf16 v[104:107], a[136:139], v[168:171], v[104:107]
    buffer_load_dwordx4 v30, s[32:35], s54 offen nt lds
    v_cvt_pk_bf16_f32 v54, v36, v37
    v_mfma_f32_16x16x32_bf16 v[104:107], a[140:143], v[172:175], v[104:107]
    v_or3_b32 v12, v12, v53, v54
    v_cvt_pk_bf16_f32 v55, v38, v39
    v_mfma_f32_16x16x32_bf16 v[108:111], a[144:147], v[160:163], v[76:79]
    v_bitop3_b32 v12, v12, v55, s48 bitop3:0xa8
    v_cmp_ne_u32 vcc, 0, v12
    v_mfma_f32_16x16x32_bf16 v[108:111], a[148:151], v[164:167], v[108:111]
    ds_read_b128 a[168:171], v18 offset:8192
    v_mfma_f32_16x16x32_bf16 v[108:111], a[152:155], v[168:171], v[108:111]
    s_waitcnt lgkmcnt(3)
    v_exp_f32 v32, v96
    v_mfma_f32_16x16x32_bf16 v[108:111], a[156:159], v[172:175], v[108:111]
    s_cbranch_vccnz STUB_Al0
BACK_Al0:
    v_exp_f32 v33, v97
    v_mfma_f32_16x16x32_bf16 a[0:3], a[192:195], v[48:51], a[0:3]
    ds_read_b128 a[172:175], v19 offset:8192
    v_mfma_f32_16x16x32_bf16 a[32:35], a[192:195], v[52:55], a[32:35]
    buffer_load_dwordx4 v31, s[32:35], s54 offen offset:1024 nt lds
    v_mfma_f32_16x16x32_bf16 a[4:7], a[196:199], v[48:51], a[4:7]
    v_exp_f32 v34, v98
    v_mfma_f32_16x16x32_bf16 a[36:39], a[196:199], v[52:55], a[36:39]
    v_exp_f32 v35, v99
    v_mfma_f32_16x16x32_bf16 a[8:11], a[200:203], v[48:51], a[8:11]
    ds_read_b128 a[176:179], v16 offset:12288
    v_cvt_pk_bf16_f32 v56, v32, v33
    v_mfma_f32_16x16x32_bf16 a[40:43], a[200:203], v[52:55], a[40:43]
    ds_read_b128 a[180:183], v17 offset:12288
    v_mfma_f32_16x16x32_bf16 a[12:15], a[204:207], v[48:51], a[12:15]
    v_exp_f32 v36, v100
    v_mfma_f32_16x16x32_bf16 a[44:47], a[204:207], v[52:55], a[44:47]
    v_exp_f32 v37, v101
    v_mfma_f32_16x16x32_bf16 a[16:19], a[208:211], v[48:51], a[16:19]
    ds_read_b128 a[184:187], v18 offset:12288
    v_cvt_pk_bf16_f32 v57, v34, v35
    v_mfma_f32_16x16x32_bf16 a[48:51], a[208:211], v[52:55], a[48:51]
    ds_read_b128 a[188:191], v19 offset:12288
    v_mfma_f32_16x16x32_bf16 a[20:23], a[212:215], v[48:51], a[20:23]
    v_exp_f32 v38, v102
    v_mfma_f32_16x16x32_bf16 a[52:55], a[212:215], v[52:55], a[52:55]
    v_exp_f32 v39, v103
    v_mfma_f32_16x16x32_bf16 a[24:27], a[216:219], v[48:51], a[24:27]
    v_cvt_pk_bf16_f32 v58, v36, v37
    v_mfma_f32_16x16x32_bf16 a[56:59], a[216:219], v[52:55], a[56:59]
    v_or3_b32 v13, v56, v57, v58
    v_mfma_f32_16x16x32_bf16 a[28:31], a[220:223], v[48:51], a[28:31]
    v_exp_f32 v32, v104
    v_mfma_f32_16x16x32_bf16 a[60:63], a[220:223], v[52:55], a[60:63]
    v_exp_f32 v33, v105
    v_mfma_f32_16x16x32_bf16 v[196:199], v[8:11], v[48:51], v[196:199]
    v_cvt_pk_bf16_f32 v59, v38, v39
    v_mfma_f32_16x16x32_bf16 v[200:203], v[8:11], v[52:55], v[200:203]
    s_waitcnt vmcnt(8) lgkmcnt(0)
    v_mfma_f32_16x16x32_bf16 v[80:83], a[160:163], v[112:115], v[64:67]
    s_barrier
    v_exp_f32 v34, v106
    v_mfma_f32_16x16x32_bf16 v[80:83], a[164:167], v[116:119], v[80:83]
    s_mov_b32 s54, s47
    v_exp_f32 v35, v107
    v_mfma_f32_16x16x32_bf16 v[80:83], a[168:171], v[120:123], v[80:83]
    s_add_u32 s46, s46, 8192
    ds_read_b64_tr_b16 a[224:225], v20 offset:8192
    v_cvt_pk_bf16_f32 v60, v32, v33
    v_mfma_f32_16x16x32_bf16 v[80:83], a[172:175], v[124:127], v[80:83]
    s_and_b32 s46, s46, 0x3ffff
    ds_read_b64_tr_b16 a[226:227], v20 offset:12288
    v_or3_b32 v13, v13, v59, v60
    v_mfma_f32_16x16x32_bf16 v[84:87], a[176:179], v[112:115], v[64:67]
    s_cmp_lt_u32 s55, 32
    v_exp_f32 v36, v108
    v_mfma_f32_16x16x32_bf16 v[84:87], a[180:183], v[116:119], v[84:87]
    s_cselect_b32 s47, s46, 0x40000
    v_exp_f32 v37, v109
    v_mfma_f32_16x16x32_bf16 v[84:87], a[184:187], v[120:123], v[84:87]
    s_add_u32 s55, s55, 1
    ds_read_b64_tr_b16 a[228:229], v21 offset:8192
    v_cvt_pk_bf16_f32 v61, v34, v35
    v_mfma_f32_16x16x32_bf16 v[84:87], a[188:191], v[124:127], v[84:87]
    s_add_u32 m0, s27, 8192
    ds_read_b64_tr_b16 a[230:231], v21 offset:12288
    v_mfma_f32_16x16x32_bf16 v[88:91], a[160:163], v[128:131], v[68:71]
    v_exp_f32 v38, v110
    v_mfma_f32_16x16x32_bf16 v[88:91], a[164:167], v[132:135], v[88:91]
    v_exp_f32 v39, v111
    v_mfma_f32_16x16x32_bf16 v[88:91], a[168:171], v[136:139], v[88:91]
    ds_read_b64_tr_b16 a[232:233], v22 offset:8192
    v_cvt_pk_bf16_f32 v62, v36, v37
    v_mfma_f32_16x16x32_bf16 v[88:91], a[172:175], v[140:143], v[88:91]
    v_or3_b32 v13, v13, v61, v62
    v_cvt_pk_bf16_f32 v63, v38, v39
    v_mfma_f32_16x16x32_bf16 v[92:95], a[176:179], v[128:131], v[68:71]
    v_bitop3_b32 v13, v13, v63, s48 bitop3:0xa8
    v_cmp_ne_u32 vcc, 0, v13
    v_mfma_f32_16x16x32_bf16 v[92:95], a[180:183], v[132:135], v[92:95]
    ds_read_b64_tr_b16 a[234:235], v22 offset:12288
    v_mfma_f32_16x16x32_bf16 v[92:95], a[184:187], v[136:139], v[92:95]
    v_exp_f32 v32, v80
    v_mfma_f32_16x16x32_bf16 v[92:95], a[188:191], v[140:143], v[92:95]
    s_cbranch_vccnz STUB_Bl1
BACK_Bl1:
    v_exp_f32 v33, v81
    v_mfma_f32_16x16x32_bf16 a[64:67], a[192:195], v[56:59], a[64:67]
    buffer_load_dwordx4 v28, s[28:31], s47 offen nt lds
    v_mfma_f32_16x16x32_bf16 a[96:99], a[192:195], v[60:63], a[96:99]
    ds_read_b64_tr_b16 a[236:237], v23 offset:8192
    v_mfma_f32_16x16x32_bf16 a[68:71], a[196:199], v[56:59], a[68:71]
    v_exp_f32 v34, v82
    v_mfma_f32_16x16x32_bf16 a[100:103], a[196:199], v[60:63], a[100:103]
    v_exp_f32 v35, v83
    v_mfma_f32_16x16x32_bf16 a[72:75], a[200:203], v[56:59], a[72:75]
    ds_read_b64_tr_b16 a[238:239], v23 offset:12288
    v_cvt_pk_bf16_f32 v48, v32, v33
    v_mfma_f32_16x16x32_bf16 a[104:107], a[200:203], v[60:63], a[104:107]
    ds_read_b64_tr_b16 a[240:241], v24 offset:8192
    v_mfma_f32_16x16x32_bf16 a[76:79], a[204:207], v[56:59], a[76:79]
    v_exp_f32 v36, v84
    v_mfma_f32_16x16x32_bf16 a[108:111], a[204:207], v[60:63], a[108:111]
    v_exp_f32 v37, v85
    v_mfma_f32_16x16x32_bf16 a[80:83], a[208:211], v[56:59], a[80:83]
    ds_read_b64_tr_b16 a[242:243], v24 offset:12288
    v_cvt_pk_bf16_f32 v49, v34, v35
    v_mfma_f32_16x16x32_bf16 a[112:115], a[208:211], v[60:63], a[112:115]
    buffer_load_dwordx4 v29, s[28:31], s47 offen offset:1024 nt lds
    v_mfma_f32_16x16x32_bf16 a[84:87], a[212:215], v[56:59], a[84:87]
    s_add_u32 m0, s27, 65536
    v_exp_f32 v38, v86
    v_mfma_f32_16x16x32_bf16 a[116:119], a[212:215], v[60:63], a[116:119]
    v_exp_f32 v39, v87
    v_mfma_f32_16x16x32_bf16 a[88:91], a[216:219], v[56:59], a[88:91]
    ds_read_b64_tr_b16 a[244:245], v25 offset:8192
    v_cvt_pk_bf16_f32 v50, v36, v37
    v_mfma_f32_16x16x32_bf16 a[120:123], a[216:219], v[60:63], a[120:123]
    ds_read_b64_tr_b16 a[246:247], v25 offset:12288
    v_or3_b32 v12, v48, v49, v50
    v_mfma_f32_16x16x32_bf16 a[92:95], a[220:223], v[56:59], a[92:95]
    v_exp_f32 v32, v88
    v_mfma_f32_16x16x32_bf16 a[124:127], a[220:223], v[60:63], a[124:127]
    v_exp_f32 v33, v89
    v_mfma_f32_16x16x32_bf16 v[204:207], v[8:11], v[56:59], v[204:207]
    ds_read_b64_tr_b16 a[248:249], v26 offset:8192
    v_cvt_pk_bf16_f32 v51, v38, v39
    v_mfma_f32_16x16x32_bf16 v[208:211], v[8:11], v[60:63], v[208:211]
    ds_read_b64_tr_b16 a[250:251], v26 offset:12288
    v_mfma_f32_16x16x32_bf16 v[96:99], a[160:163], v[144:147], v[72:75]
    v_exp_f32 v34, v90
    v_mfma_f32_16x16x32_bf16 v[96:99], a[164:167], v[148:151], v[96:99]
    v_exp_f32 v35, v91
    v_mfma_f32_16x16x32_bf16 v[96:99], a[168:171], v[152:155], v[96:99]
    ds_read_b64_tr_b16 a[252:253], v27 offset:8192
    v_cvt_pk_bf16_f32 v52, v32, v33
    v_mfma_f32_16x16x32_bf16 v[96:99], a[172:175], v[156:159], v[96:99]
    ds_read_b64_tr_b16 a[254:255], v27 offset:12288
    v_or3_b32 v12, v12, v51, v52
    v_mfma_f32_16x16x32_bf16 v[100:103], a[176:179], v[144:147], v[72:75]
    v_exp_f32 v36, v92
    v_mfma_f32_16x16x32_bf16 v[100:103], a[180:183], v[148:151], v[100:103]
    v_exp_f32 v37, v93
    v_mfma_f32_16x16x32_bf16 v[100:103], a[184:187], v[152:155], v[100:103]
    ds_read_b128 a[128:131], v16 offset:16384
    v_cvt_pk_bf16_f32 v53, v34, v35
    v_mfma_f32_16x16x32_bf16 v[100:103], a[188:191], v[156:159], v[100:103]
    ds_read_b128 a[132:135], v17 offset:16384
    v_mfma_f32_16x16x32_bf16 v[104:107], a[160:163], v[160:163], v[76:79]
    v_exp_f32 v38, v94
    v_mfma_f32_16x16x32_bf16 v[104:107], a[164:167], v[164:167], v[104:107]
    v_exp_f32 v39, v95
    v_mfma_f32_16x16x32_bf16 v[104:107], a[168:171], v[168:171], v[104:107]
    buffer_load_dwordx4 v30, s[32:35], s54 offen nt lds
    v_cvt_pk_bf16_f32 v54, v36, v37
    v_mfma_f32_16x16x32_bf16 v[104:107], a[172:175], v[172:175], v[104:107]
    v_or3_b32 v12, v12, v53, v54
    v_cvt_pk_bf16_f32 v55, v38, v39
    v_mfma_f32_16x16x32_bf16 v[108:111], a[176:179], v[160:163], v[76:79]
    v_bitop3_b32 v12, v12, v55, s48 bitop3:0xa8
    v_cmp_ne_u32 vcc, 0, v12
    v_mfma_f32_16x16x32_bf16 v[108:111], a[180:183], v[164:167], v[108:111]
    ds_read_b128 a[136:139], v18 offset:16384
    v_mfma_f32_16x16x32_bf16 v[108:111], a[184:187], v[168:171], v[108:111]
    s_waitcnt lgkmcnt(3)
    v_exp_f32 v32, v96
    v_mfma_f32_16x16x32_bf16 v[108:111], a[188:191], v[172:175], v[108:111]
    s_cbranch_vccnz STUB_Al1
BACK_Al1:
    v_exp_f32 v33, v97
    v_mfma_f32_16x16x32_bf16 a[0:3], a[224:227], v[48:51], a[0:3]
    ds_read_b128 a[140:143], v19 offset:16384
    v_mfma_f32_16x16x32_bf16 a[32:35], a[224:227], v[52:55], a[32:35]
    buffer_load_dwordx4 v31, s[32:35], s54 offen offset:1024 nt lds
    v_mfma_f32_16x16x32_bf16 a[4:7], a[228:231], v[48:51], a[4:7]
    v_exp_f32 v34, v98
    v_mfma_f32_16x16x32_bf16 a[36:39], a[228:231], v[52:55], a[36:39]
    v_exp_f32 v35, v99
    v_mfma_f32_16x16x32_bf16 a[8:11], a[232:235], v[48:51], a[8:11]
    ds_read_b128 a[144:147], v16 offset:20480
    v_cvt_pk_bf16_f32 v56, v32, v33
    v_mfma_f32_16x16x32_bf16 a[40:43], a[232:235], v[52:55], a[40:43]
    ds_read_b128 a[148:151], v17 offset:20480
    v_mfma_f32_16x16x32_bf16 a[12:15], a[236:239], v[48:51], a[12:15]
    v_exp_f32 v36, v100
    v_mfma_f32_16x16x32_bf16 a[44:47], a[236:239], v[52:55], a[44:47]
    v_exp_f32 v37, v101
    v_mfma_f32_16x16x32_bf16 a[16:19], a[240:243], v[48:51], a[16:19]
    ds_read_b128 a[152:155], v18 offset:20480
    v_cvt_pk_bf16_f32 v57, v34, v35
    v_mfma_f32_16x16x32_bf16 a[48:51], a[240:243], v[52:55], a[48:51]
    ds_read_b128 a[156:159], v19 offset:20480
    v_mfma_f32_16x16x32_bf16 a[20:23], a[244:247], v[48:51], a[20:23]
    v_exp_f32 v38, v102
    v_mfma_f32_16x16x32_bf16 a[52:55], a[244:247], v[52:55], a[52:55]
    v_exp_f32 v39, v103
    v_mfma_f32_16x16x32_bf16 a[24:27], a[248:251], v[48:51], a[24:27]
    v_cvt_pk_bf16_f32 v58, v36, v37
    v_mfma_f32_16x16x32_bf16 a[56:59], a[248:251], v[52:55], a[56:59]
    v_or3_b32 v13, v56, v57, v58
    v_mfma_f32_16x16x32_bf16 a[28:31], a[252:255], v[48:51], a[28:31]
    v_exp_f32 v32, v104
    v_mfma_f32_16x16x32_bf16 a[60:63], a[252:255], v[52:55], a[60:63]
    v_exp_f32 v33, v105
    v_mfma_f32_16x16x32_bf16 v[196:199], v[8:11], v[48:51], v[196:199]
    v_cvt_pk_bf16_f32 v59, v38, v39
    v_mfma_f32_16x16x32_bf16 v[200:203], v[8:11], v[52:55], v[200:203]
    s_waitcnt vmcnt(8) lgkmcnt(0)
LOOP_P2:
    v_mfma_f32_16x16x32_bf16 v[80:83], a[128:131], v[112:115], v[64:67]
    s_barrier
    v_exp_f32 v34, v106
    v_mfma_f32_16x16x32_bf16 v[80:83], a[132:135], v[116:119], v[80:83]
    s_mov_b32 s54, s47
    v_exp_f32 v35, v107
    v_mfma_f32_16x16x32_bf16 v[80:83], a[136:139], v[120:123], v[80:83]
    s_add_u32 s46, s46, 8192
    ds_read_b64_tr_b16 a[192:193], v20 offset:16384
    v_cvt_pk_bf16_f32 v60, v32, v33
    v_mfma_f32_16x16x32_bf16 v[80:83], a[140:143], v[124:127], v[80:83]
    s_and_b32 s46, s46, 0x3ffff
    ds_read_b64_tr_b16 a[194:195], v20 offset:20480
    v_or3_b32 v13, v13, v59, v60
    v_mfma_f32_16x16x32_bf16 v[84:87], a[144:147], v[112:115], v[64:67]
    s_cmp_lt_u32 s55, 32
    v_exp_f32 v36, v108
    v_mfma_f32_16x16x32_bf16 v[84:87], a[148:151], v[116:119], v[84:87]
    s_cselect_b32 s47, s46, 0x40000
    v_exp_f32 v37, v109
    v_mfma_f32_16x16x32_bf16 v[84:87], a[152:155], v[120:123], v[84:87]
    s_add_u32 s55, s55, 1
    ds_read_b64_tr_b16 a[196:197], v21 offset:16384
    v_cvt_pk_bf16_f32 v61, v34, v35
    v_mfma_f32_16x16x32_bf16 v[84:87], a[156:159], v[124:127], v[84:87]
    s_add_u32 m0, s27, 16384
    ds_read_b64_tr_b16 a[198:199], v21 offset:20480
    v_mfma_f32_16x16x32_bf16 v[88:91], a[128:131], v[128:131], v[68:71]
    v_exp_f32 v38, v110
    v_mfma_f32_16x16x32_bf16 v[88:91], a[132:135], v[132:135], v[88:91]
    v_exp_f32 v39, v111
    v_mfma_f32_16x16x32_bf16 v[88:91], a[136:139], v[136:139], v[88:91]
    ds_read_b64_tr_b16 a[200:201], v22 offset:16384
    v_cvt_pk_bf16_f32 v62, v36, v37
    v_mfma_f32_16x16x32_bf16 v[88:91], a[140:143], v[140:143], v[88:91]
    v_or3_b32 v13, v13, v61, v62
    v_cvt_pk_bf16_f32 v63, v38, v39
    v_mfma_f32_16x16x32_bf16 v[92:95], a[144:147], v[128:131], v[68:71]
    v_bitop3_b32 v13, v13, v63, s48 bitop3:0xa8
    v_cmp_ne_u32 vcc, 0, v13
    v_mfma_f32_16x16x32_bf16 v[92:95], a[148:151], v[132:135], v[92:95]
    ds_read_b64_tr_b16 a[202:203], v22 offset:20480
    v_mfma_f32_16x16x32_bf16 v[92:95], a[152:155], v[136:139], v[92:95]
    v_exp_f32 v32, v80
    v_mfma_f32_16x16x32_bf16 v[92:95], a[156:159], v[140:143], v[92:95]
    s_cbranch_vccnz STUB_Bl2
BACK_Bl2:
    v_exp_f32 v33, v81
    v_mfma_f32_16x16x32_bf16 a[64:67], a[224:227], v[56:59], a[64:67]
    buffer_load_dwordx4 v28, s[28:31], s47 offen nt lds
    v_mfma_f32_16x16x32_bf16 a[96:99], a[224:227], v[60:63], a[96:99]
    ds_read_b64_tr_b16 a[204:205], v23 offset:16384
    v_mfma_f32_16x16x32_bf16 a[68:71], a[228:231], v[56:59], a[68:71]
    v_exp_f32 v34, v82
    v_mfma_f32_16x16x32_bf16 a[100:103], a[228:231], v[60:63], a[100:103]
    v_exp_f32 v35, v83
    v_mfma_f32_16x16x32_bf16 a[72:75], a[232:235], v[56:59], a[72:75]
    ds_read_b64_tr_b16 a[206:207], v23 offset:20480
    v_cvt_pk_bf16_f32 v48, v32, v33
    v_mfma_f32_16x16x32_bf16 a[104:107], a[232:235], v[60:63], a[104:107]
    ds_read_b64_tr_b16 a[208:209], v24 offset:16384
    v_mfma_f32_16x16x32_bf16 a[76:79], a[236:239], v[56:59], a[76:79]
    v_exp_f32 v36, v84
    v_mfma_f32_16x16x32_bf16 a[108:111], a[236:239], v[60:63], a[108:111]
    v_exp_f32 v37, v85
    v_mfma_f32_16x16x32_bf16 a[80:83], a[240:243], v[56:59], a[80:83]
    ds_read_b64_tr_b16 a[210:211], v24 offset:20480
    v_cvt_pk_bf16_f32 v49, v34, v35
    v_mfma_f32_16x16x32_bf16 a[112:115], a[240:243], v[60:63], a[112:115]
    buffer_load_dwordx4 v29, s[28:31], s47 offen offset:1024 nt lds
    v_mfma_f32_16x16x32_bf16 a[84:87], a[244:247], v[56:59], a[84:87]
    s_add_u32 m0, s27, 73728
    v_exp_f32 v38, v86
    v_mfma_f32_16x16x32_bf16 a[116:119], a[244:247], v[60:63], a[116:119]
    v_exp_f32 v39, v87
    v_mfma_f32_16x16x32_bf16 a[88:91], a[248:251], v[56:59], a[88:91]
    ds_read_b64_tr_b16 a[212:213], v25 offset:16384
    v_cvt_pk_bf16_f32 v50, v36, v37
    v_mfma_f32_16x16x32_bf16 a[120:123], a[248:251], v[60:63], a[120:123]
    ds_read_b64_tr_b16 a[214:215], v25 offset:20480
    v_or3_b32 v12, v48, v49, v50
    v_mfma_f32_16x16x32_bf16 a[92:95], a[252:255], v[56:59], a[92:95]
    v_exp_f32 v32, v88
    v_mfma_f32_16x16x32_bf16 a[124:127], a[252:255], v[60:63], a[124:127]
    v_exp_f32 v33, v89
    v_mfma_f32_16x16x32_bf16 v[204:207], v[8:11], v[56:59], v[204:207]
    ds_read_b64_tr_b16 a[216:217], v26 offset:16384
    v_cvt_pk_bf16_f32 v51, v38, v39
    v_mfma_f32_16x16x32_bf16 v[208:211], v[8:11], v[60:63], v[208:211]
    ds_read_b64_tr_b16 a[218:219], v26 offset:20480
    v_mfma_f32_16x16x32_bf16 v[96:99], a[128:131], v[144:147], v[72:75]
    v_exp_f32 v34, v90
    v_mfma_f32_16x16x32_bf16 v[96:99], a[132:135], v[148:151], v[96:99]
    v_exp_f32 v35, v91
    v_mfma_f32_16x16x32_bf16 v[96:99], a[136:139], v[152:155], v[96:99]
    ds_read_b64_tr_b16 a[220:221], v27 offset:16384
    v_cvt_pk_bf16_f32 v52, v32, v33
    v_mfma_f32_16x16x32_bf16 v[96:99], a[140:143], v[156:159], v[96:99]
    ds_read_b64_tr_b16 a[222:223], v27 offset:20480
    v_or3_b32 v12, v12, v51, v52
    v_mfma_f32_16x16x32_bf16 v[100:103], a[144:147], v[144:147], v[72:75]
    v_exp_f32 v36, v92
    v_mfma_f32_16x16x32_bf16 v[100:103], a[148:151], v[148:151], v[100:103]
    v_exp_f32 v37, v93
    v_mfma_f32_16x16x32_bf16 v[100:103], a[152:155], v[152:155], v[100:103]
    ds_read_b128 a[160:163], v16 offset:24576
    v_cvt_pk_bf16_f32 v53, v34, v35
    v_mfma_f32_16x16x32_bf16 v[100:103], a[156:159], v[156:159], v[100:103]
    ds_read_b128 a[164:167], v17 offset:24576
    v_mfma_f32_16x16x32_bf16 v[104:107], a[128:131], v[160:163], v[76:79]
    v_exp_f32 v38, v94
    v_mfma_f32_16x16x32_bf16 v[104:107], a[132:135], v[164:167], v[104:107]
    v_exp_f32 v39, v95
    v_mfma_f32_16x16x32_bf16 v[104:107], a[136:139], v[168:171], v[104:107]
    buffer_load_dwordx4 v30, s[32:35], s54 offen nt lds
    v_cvt_pk_bf16_f32 v54, v36, v37
    v_mfma_f32_16x16x32_bf16 v[104:107], a[140:143], v[172:175], v[104:107]
    v_or3_b32 v12, v12, v53, v54
    v_cvt_pk_bf16_f32 v55, v38, v39
    v_mfma_f32_16x16x32_bf16 v[108:111], a[144:147], v[160:163], v[76:79]
    v_bitop3_b32 v12, v12, v55, s48 bitop3:0xa8
    v_cmp_ne_u32 vcc, 0, v12
    v_mfma_f32_16x16x32_bf16 v[108:111], a[148:151], v[164:167], v[108:111]
    ds_read_b128 a[168:171], v18 offset:24576
    v_mfma_f32_16x16x32_bf16 v[108:111], a[152:155], v[168:171], v[108:111]
    s_waitcnt lgkmcnt(3)
    v_exp_f32 v32, v96
    v_mfma_f32_16x16x32_bf16 v[108:111], a[156:159], v[172:175], v[108:111]
    s_cbranch_vccnz STUB_Al2
BACK_Al2:
    v_exp_f32 v33, v97
    v_mfma_f32_16x16x32_bf16 a[0:3], a[192:195], v[48:51], a[0:3]
    ds_read_b128 a[172:175], v19 offset:24576
    v_mfma_f32_16x16x32_bf16 a[32:35], a[192:195], v[52:55], a[32:35]
    buffer_load_dwordx4 v31, s[32:35], s54 offen offset:1024 nt lds
    v_mfma_f32_16x16x32_bf16 a[4:7], a[196:199], v[48:51], a[4:7]
    v_exp_f32 v34, v98
    v_mfma_f32_16x16x32_bf16 a[36:39], a[196:199], v[52:55], a[36:39]
    v_exp_f32 v35, v99
    v_mfma_f32_16x16x32_bf16 a[8:11], a[200:203], v[48:51], a[8:11]
    ds_read_b128 a[176:179], v16 offset:28672
    v_cvt_pk_bf16_f32 v56, v32, v33
    v_mfma_f32_16x16x32_bf16 a[40:43], a[200:203], v[52:55], a[40:43]
    ds_read_b128 a[180:183], v17 offset:28672
    v_mfma_f32_16x16x32_bf16 a[12:15], a[204:207], v[48:51], a[12:15]
    v_exp_f32 v36, v100
    v_mfma_f32_16x16x32_bf16 a[44:47], a[204:207], v[52:55], a[44:47]
    v_exp_f32 v37, v101
    v_mfma_f32_16x16x32_bf16 a[16:19], a[208:211], v[48:51], a[16:19]
    ds_read_b128 a[184:187], v18 offset:28672
    v_cvt_pk_bf16_f32 v57, v34, v35
    v_mfma_f32_16x16x32_bf16 a[48:51], a[208:211], v[52:55], a[48:51]
    ds_read_b128 a[188:191], v19 offset:28672
    v_mfma_f32_16x16x32_bf16 a[20:23], a[212:215], v[48:51], a[20:23]
    v_exp_f32 v38, v102
    v_mfma_f32_16x16x32_bf16 a[52:55], a[212:215], v[52:55], a[52:55]
    v_exp_f32 v39, v103
    v_mfma_f32_16x16x32_bf16 a[24:27], a[216:219], v[48:51], a[24:27]
    v_cvt_pk_bf16_f32 v58, v36, v37
    v_mfma_f32_16x16x32_bf16 a[56:59], a[216:219], v[52:55], a[56:59]
    v_or3_b32 v13, v56, v57, v58
    v_mfma_f32_16x16x32_bf16 a[28:31], a[220:223], v[48:51], a[28:31]
    v_exp_f32 v32, v104
    v_mfma_f32_16x16x32_bf16 a[60:63], a[220:223], v[52:55], a[60:63]
    v_exp_f32 v33, v105
    v_mfma_f32_16x16x32_bf16 v[196:199], v[8:11], v[48:51], v[196:199]
    v_cvt_pk_bf16_f32 v59, v38, v39
    v_mfma_f32_16x16x32_bf16 v[200:203], v[8:11], v[52:55], v[200:203]
    s_waitcnt vmcnt(8) lgkmcnt(0)
    v_mfma_f32_16x16x32_bf16 v[80:83], a[160:163], v[112:115], v[64:67]
    s_barrier
    v_exp_f32 v34, v106
    v_mfma_f32_16x16x32_bf16 v[80:83], a[164:167], v[116:119], v[80:83]
    s_mov_b32 s54, s47
    v_exp_f32 v35, v107
    v_mfma_f32_16x16x32_bf16 v[80:83], a[168:171], v[120:123], v[80:83]
    s_add_u32 s46, s46, 8192
    ds_read_b64_tr_b16 a[224:225], v20 offset:24576
    v_cvt_pk_bf16_f32 v60, v32, v33
    v_mfma_f32_16x16x32_bf16 v[80:83], a[172:175], v[124:127], v[80:83]
    s_and_b32 s46, s46, 0x3ffff
    ds_read_b64_tr_b16 a[226:227], v20 offset:28672
    v_or3_b32 v13, v13, v59, v60
    v_mfma_f32_16x16x32_bf16 v[84:87], a[176:179], v[112:115], v[64:67]
    s_cmp_lt_u32 s55, 32
    v_exp_f32 v36, v108
    v_mfma_f32_16x16x32_bf16 v[84:87], a[180:183], v[116:119], v[84:87]
    s_cselect_b32 s47, s46, 0x40000
    v_exp_f32 v37, v109
    v_mfma_f32_16x16x32_bf16 v[84:87], a[184:187], v[120:123], v[84:87]
    s_add_u32 s55, s55, 1
    ds_read_b64_tr_b16 a[228:229], v21 offset:24576
    v_cvt_pk_bf16_f32 v61, v34, v35
    v_mfma_f32_16x16x32_bf16 v[84:87], a[188:191], v[124:127], v[84:87]
    s_add_u32 m0, s27, 24576
    ds_read_b64_tr_b16 a[230:231], v21 offset:28672
    v_xor_b32 v16, 0x8000, v16
    v_mfma_f32_16x16x32_bf16 v[88:91], a[160:163], v[128:131], v[68:71]
    v_exp_f32 v38, v110
    v_mfma_f32_16x16x32_bf16 v[88:91], a[164:167], v[132:135], v[88:91]
    v_exp_f32 v39, v111
    v_mfma_f32_16x16x32_bf16 v[88:91], a[168:171], v[136:139], v[88:91]
    ds_read_b64_tr_b16 a[232:233], v22 offset:24576
    v_cvt_pk_bf16_f32 v62, v36, v37
    v_mfma_f32_16x16x32_bf16 v[88:91], a[172:175], v[140:143], v[88:91]
    v_or3_b32 v13, v13, v61, v62
    v_cvt_pk_bf16_f32 v63, v38, v39
    v_mfma_f32_16x16x32_bf16 v[92:95], a[176:179], v[128:131], v[68:71]
    v_bitop3_b32 v13, v13, v63, s48 bitop3:0xa8
    v_cmp_ne_u32 vcc, 0, v13
    v_mfma_f32_16x16x32_bf16 v[92:95], a[180:183], v[132:135], v[92:95]
    ds_read_b64_tr_b16 a[234:235], v22 offset:28672
    v_xor_b32 v17, 0x8000, v17
    v_mfma_f32_16x16x32_bf16 v[92:95], a[184:187], v[136:139], v[92:95]
    v_exp_f32 v32, v80
    v_mfma_f32_16x16x32_bf16 v[92:95], a[188:191], v[140:143], v[92:95]
    s_cbranch_vccnz STUB_Bl3
BACK_Bl3:
    v_exp_f32 v33, v81
    v_mfma_f32_16x16x32_bf16 a[64:67], a[192:195], v[56:59], a[64:67]
    buffer_load_dwordx4 v28, s[28:31], s47 offen nt lds
    v_xor_b32 v18, 0x8000, v18
    v_mfma_f32_16x16x32_bf16 a[96:99], a[192:195], v[60:63], a[96:99]
    ds_read_b64_tr_b16 a[236:237], v23 offset:24576
    v_xor_b32 v19, 0x8000, v19
    v_mfma_f32_16x16x32_bf16 a[68:71], a[196:199], v[56:59], a[68:71]
    v_exp_f32 v34, v82
    v_mfma_f32_16x16x32_bf16 a[100:103], a[196:199], v[60:63], a[100:103]
    v_exp_f32 v35, v83
    v_mfma_f32_16x16x32_bf16 a[72:75], a[200:203], v[56:59], a[72:75]
    ds_read_b64_tr_b16 a[238:239], v23 offset:28672
    v_cvt_pk_bf16_f32 v48, v32, v33
    v_mfma_f32_16x16x32_bf16 a[104:107], a[200:203], v[60:63], a[104:107]
    ds_read_b64_tr_b16 a[240:241], v24 offset:24576
    v_xor_b32 v20, 0x8000, v20
    v_mfma_f32_16x16x32_bf16 a[76:79], a[204:207], v[56:59], a[76:79]
    v_exp_f32 v36, v84
    v_mfma_f32_16x16x32_bf16 a[108:111], a[204:207], v[60:63], a[108:111]
    v_exp_f32 v37, v85
    v_mfma_f32_16x16x32_bf16 a[80:83], a[208:211], v[56:59], a[80:83]
    ds_read_b64_tr_b16 a[242:243], v24 offset:28672
    v_cvt_pk_bf16_f32 v49, v34, v35
    v_mfma_f32_16x16x32_bf16 a[112:115], a[208:211], v[60:63], a[112:115]
    buffer_load_dwordx4 v29, s[28:31], s47 offen offset:1024 nt lds
    v_xor_b32 v21, 0x8000, v21
    v_mfma_f32_16x16x32_bf16 a[84:87], a[212:215], v[56:59], a[84:87]
    s_add_u32 m0, s27, 81920
    v_exp_f32 v38, v86
    v_mfma_f32_16x16x32_bf16 a[116:119], a[212:215], v[60:63], a[116:119]
    v_exp_f32 v39, v87
    v_mfma_f32_16x16x32_bf16 a[88:91], a[216:219], v[56:59], a[88:91]
    ds_read_b64_tr_b16 a[244:245], v25 offset:24576
    v_cvt_pk_bf16_f32 v50, v36, v37
    v_mfma_f32_16x16x32_bf16 a[120:123], a[216:219], v[60:63], a[120:123]
    ds_read_b64_tr_b16 a[246:247], v25 offset:28672
    v_or3_b32 v12, v48, v49, v50
    v_mfma_f32_16x16x32_bf16 a[92:95], a[220:223], v[56:59], a[92:95]
    v_exp_f32 v32, v88
    v_mfma_f32_16x16x32_bf16 a[124:127], a[220:223], v[60:63], a[124:127]
    v_exp_f32 v33, v89
    v_mfma_f32_16x16x32_bf16 v[204:207], v[8:11], v[56:59], v[204:207]
    ds_read_b64_tr_b16 a[248:249], v26 offset:24576
    v_cvt_pk_bf16_f32 v51, v38, v39
    v_mfma_f32_16x16x32_bf16 v[208:211], v[8:11], v[60:63], v[208:211]
    ds_read_b64_tr_b16 a[250:251], v26 offset:28672
    v_xor_b32 v22, 0x8000, v22
    v_mfma_f32_16x16x32_bf16 v[96:99], a[160:163], v[144:147], v[72:75]
    v_exp_f32 v34, v90
    v_mfma_f32_16x16x32_bf16 v[96:99], a[164:167], v[148:151], v[96:99]
    v_exp_f32 v35, v91
    v_mfma_f32_16x16x32_bf16 v[96:99], a[168:171], v[152:155], v[96:99]
    ds_read_b64_tr_b16 a[252:253], v27 offset:24576
    v_cvt_pk_bf16_f32 v52, v32, v33
    v_mfma_f32_16x16x32_bf16 v[96:99], a[172:175], v[156:159], v[96:99]
    ds_read_b64_tr_b16 a[254:255], v27 offset:28672
    v_or3_b32 v12, v12, v51, v52
    v_mfma_f32_16x16x32_bf16 v[100:103], a[176:179], v[144:147], v[72:75]
    v_exp_f32 v36, v92
    v_mfma_f32_16x16x32_bf16 v[100:103], a[180:183], v[148:151], v[100:103]
    v_exp_f32 v37, v93
    v_mfma_f32_16x16x32_bf16 v[100:103], a[184:187], v[152:155], v[100:103]
    ds_read_b128 a[128:131], v16 offset:0
    v_cvt_pk_bf16_f32 v53, v34, v35
    v_mfma_f32_16x16x32_bf16 v[100:103], a[188:191], v[156:159], v[100:103]
    ds_read_b128 a[132:135], v17 offset:0
    v_xor_b32 v23, 0x8000, v23
    v_mfma_f32_16x16x32_bf16 v[104:107], a[160:163], v[160:163], v[76:79]
    v_exp_f32 v38, v94
    v_mfma_f32_16x16x32_bf16 v[104:107], a[164:167], v[164:167], v[104:107]
    v_exp_f32 v39, v95
    v_mfma_f32_16x16x32_bf16 v[104:107], a[168:171], v[168:171], v[104:107]
    buffer_load_dwordx4 v30, s[32:35], s54 offen nt lds
    v_cvt_pk_bf16_f32 v54, v36, v37
    v_mfma_f32_16x16x32_bf16 v[104:107], a[172:175], v[172:175], v[104:107]
    v_or3_b32 v12, v12, v53, v54
    v_cvt_pk_bf16_f32 v55, v38, v39
    v_mfma_f32_16x16x32_bf16 v[108:111], a[176:179], v[160:163], v[76:79]
    v_bitop3_b32 v12, v12, v55, s48 bitop3:0xa8
    v_cmp_ne_u32 vcc, 0, v12
    v_mfma_f32_16x16x32_bf16 v[108:111], a[180:183], v[164:167], v[108:111]
    ds_read_b128 a[136:139], v18 offset:0
    v_xor_b32 v24, 0x8000, v24
    v_mfma_f32_16x16x32_bf16 v[108:111], a[184:187], v[168:171], v[108:111]
    s_waitcnt lgkmcnt(3)
    v_exp_f32 v32, v96
    v_mfma_f32_16x16x32_bf16 v[108:111], a[188:191], v[172:175], v[108:111]
    s_cbranch_vccnz STUB_Al3
BACK_Al3:
    v_exp_f32 v33, v97
    v_mfma_f32_16x16x32_bf16 a[0:3], a[224:227], v[48:51], a[0:3]
    ds_read_b128 a[140:143], v19 offset:0
    v_xor_b32 v25, 0x8000, v25
    v_mfma_f32_16x16x32_bf16 a[32:35], a[224:227], v[52:55], a[32:35]
    buffer_load_dwordx4 v31, s[32:35], s54 offen offset:1024 nt lds
    v_xor_b32 v26, 0x8000, v26
    v_mfma_f32_16x16x32_bf16 a[4:7], a[228:231], v[48:51], a[4:7]
    s_xor_b32 s26, s26, 0x8000
    v_exp_f32 v34, v98
    v_mfma_f32_16x16x32_bf16 a[36:39], a[228:231], v[52:55], a[36:39]
    s_xor_b32 s27, s27, 0x8000
    v_exp_f32 v35, v99
    v_mfma_f32_16x16x32_bf16 a[8:11], a[232:235], v[48:51], a[8:11]
    s_sub_u32 s51, s51, 1
    ds_read_b128 a[144:147], v16 offset:4096
    v_cvt_pk_bf16_f32 v56, v32, v33
    v_mfma_f32_16x16x32_bf16 a[40:43], a[232:235], v[52:55], a[40:43]
    s_cmp_lg_u32 s51, 0
    ds_read_b128 a[148:151], v17 offset:4096
    v_xor_b32 v27, 0x8000, v27
    v_mfma_f32_16x16x32_bf16 a[12:15], a[236:239], v[48:51], a[12:15]
    v_exp_f32 v36, v100
    v_mfma_f32_16x16x32_bf16 a[44:47], a[236:239], v[52:55], a[44:47]
    v_exp_f32 v37, v101
    v_mfma_f32_16x16x32_bf16 a[16:19], a[240:243], v[48:51], a[16:19]
    ds_read_b128 a[152:155], v18 offset:4096
    v_cvt_pk_bf16_f32 v57, v34, v35
    v_mfma_f32_16x16x32_bf16 a[48:51], a[240:243], v[52:55], a[48:51]
    ds_read_b128 a[156:159], v19 offset:4096
    v_mfma_f32_16x16x32_bf16 a[20:23], a[244:247], v[48:51], a[20:23]
    v_exp_f32 v38, v102
    v_mfma_f32_16x16x32_bf16 a[52:55], a[244:247], v[52:55], a[52:55]
    v_exp_f32 v39, v103
    v_mfma_f32_16x16x32_bf16 a[24:27], a[248:251], v[48:51], a[24:27]
    v_cvt_pk_bf16_f32 v58, v36, v37
    v_mfma_f32_16x16x32_bf16 a[56:59], a[248:251], v[52:55], a[56:59]
    v_or3_b32 v13, v56, v57, v58
    v_mfma_f32_16x16x32_bf16 a[28:31], a[252:255], v[48:51], a[28:31]
    v_exp_f32 v32, v104
    v_mfma_f32_16x16x32_bf16 a[60:63], a[252:255], v[52:55], a[60:63]
    v_exp_f32 v33, v105
    v_mfma_f32_16x16x32_bf16 v[196:199], v[8:11], v[48:51], v[196:199]
    v_cvt_pk_bf16_f32 v59, v38, v39
    v_mfma_f32_16x16x32_bf16 v[200:203], v[8:11], v[52:55], v[200:203]
    s_waitcnt vmcnt(8) lgkmcnt(0)
    s_cbranch_scc1 LOOP
    v_mfma_f32_16x16x32_bf16 v[80:83], a[128:131], v[112:115], v[64:67]
    s_barrier
    s_mov_b32 s54, s47
    s_add_u32 m0, s26, 90112
    v_mov_b32 v14, 0
    buffer_load_dwordx4 v30, s[32:35], s54 offen nt lds
    buffer_load_dwordx4 v31, s[32:35], s54 offen offset:1024 nt lds
    buffer_load_dword v14, v14, s[84:87], s7 offen offset:128 sc1
    v_mfma_f32_16x16x32_bf16 v[80:83], a[132:135], v[116:119], v[80:83]
    v_exp_f32 v34, v106
    v_mfma_f32_16x16x32_bf16 v[80:83], a[136:139], v[120:123], v[80:83]
    v_exp_f32 v35, v107
    v_mfma_f32_16x16x32_bf16 v[80:83], a[140:143], v[124:127], v[80:83]
    ds_read_b128 a[160:163], v16 offset:8192
    v_cvt_pk_bf16_f32 v60, v32, v33
    v_mfma_f32_16x16x32_bf16 v[84:87], a[144:147], v[112:115], v[64:67]
    ds_read_b128 a[164:167], v17 offset:8192
    v_or3_b32 v13, v13, v59, v60
    v_mfma_f32_16x16x32_bf16 v[84:87], a[148:151], v[116:119], v[84:87]
    v_exp_f32 v36, v108
    v_mfma_f32_16x16x32_bf16 v[84:87], a[152:155], v[120:123], v[84:87]
    v_exp_f32 v37, v109
    v_mfma_f32_16x16x32_bf16 v[84:87], a[156:159], v[124:127], v[84:87]
    ds_read_b128 a[168:171], v18 offset:8192
    v_cvt_pk_bf16_f32 v61, v34, v35
    v_mfma_f32_16x16x32_bf16 v[88:91], a[128:131], v[128:131], v[68:71]
    v_exp_f32 v38, v110
    v_mfma_f32_16x16x32_bf16 v[88:91], a[132:135], v[132:135], v[88:91]
    v_exp_f32 v39, v111
    v_mfma_f32_16x16x32_bf16 v[88:91], a[136:139], v[136:139], v[88:91]
    ds_read_b128 a[172:175], v19 offset:8192
    v_cvt_pk_bf16_f32 v62, v36, v37
    v_mfma_f32_16x16x32_bf16 v[88:91], a[140:143], v[140:143], v[88:91]
    ds_read_b128 a[176:179], v16 offset:12288
    v_or3_b32 v13, v13, v61, v62
    v_mfma_f32_16x16x32_bf16 v[92:95], a[144:147], v[128:131], v[68:71]
    ds_read_b128 a[180:183], v17 offset:12288
    v_cvt_pk_bf16_f32 v63, v38, v39
    v_mfma_f32_16x16x32_bf16 v[92:95], a[148:151], v[132:135], v[92:95]
    ds_read_b128 a[184:187], v18 offset:12288
    v_bitop3_b32 v13, v13, v63, s48 bitop3:0xa8
    v_mfma_f32_16x16x32_bf16 v[92:95], a[152:155], v[136:139], v[92:95]
    ds_read_b128 a[188:191], v19 offset:12288
    v_cmp_ne_u32 vcc, 0, v13
    v_mfma_f32_16x16x32_bf16 v[92:95], a[156:159], v[140:143], v[92:95]
    v_exp_f32 v32, v80
    v_exp_f32 v33, v81
    v_exp_f32 v34, v82
    v_cvt_pk_bf16_f32 v48, v32, v33
    s_cbranch_vccnz STUB_Bt
BACK_Bt:
    v_mfma_f32_16x16x32_bf16 a[64:67], a[224:227], v[56:59], a[64:67]
    ds_read_b64_tr_b16 a[192:193], v20 offset:0
    v_exp_f32 v35, v83
    v_mfma_f32_16x16x32_bf16 a[96:99], a[224:227], v[60:63], a[96:99]
    v_exp_f32 v36, v84
    v_mfma_f32_16x16x32_bf16 a[68:71], a[228:231], v[56:59], a[68:71]
    ds_read_b64_tr_b16 a[194:195], v20 offset:4096
    v_cvt_pk_bf16_f32 v49, v34, v35
    v_mfma_f32_16x16x32_bf16 a[100:103], a[228:231], v[60:63], a[100:103]
    ds_read_b64_tr_b16 a[196:197], v21 offset:0
    v_exp_f32 v37, v85
    v_mfma_f32_16x16x32_bf16 a[72:75], a[232:235], v[56:59], a[72:75]
    ds_read_b64_tr_b16 a[198:199], v21 offset:4096
    v_exp_f32 v38, v86
    v_mfma_f32_16x16x32_bf16 a[104:107], a[232:235], v[60:63], a[104:107]
    ds_read_b64_tr_b16 a[200:201], v22 offset:0
    v_cvt_pk_bf16_f32 v50, v36, v37
    v_mfma_f32_16x16x32_bf16 a[76:79], a[236:239], v[56:59], a[76:79]
    v_exp_f32 v39, v87
    v_mfma_f32_16x16x32_bf16 a[108:111], a[236:239], v[60:63], a[108:111]
    ds_read_b64_tr_b16 a[202:203], v22 offset:4096
    v_or3_b32 v12, v48, v49, v50
    v_mfma_f32_16x16x32_bf16 a[80:83], a[240:243], v[56:59], a[80:83]
    ds_read_b64_tr_b16 a[204:205], v23 offset:0
    v_cvt_pk_bf16_f32 v51, v38, v39
    v_mfma_f32_16x16x32_bf16 a[112:115], a[240:243], v[60:63], a[112:115]
    ds_read_b64_tr_b16 a[206:207], v23 offset:4096
    v_bitop3_b32 v12, v12, v51, s48 bitop3:0xa8
    v_mfma_f32_16x16x32_bf16 a[84:87], a[244:247], v[56:59], a[84:87]
    ds_read_b64_tr_b16 a[208:209], v24 offset:0
    v_cmp_ne_u32 vcc, 0, v12
    v_mfma_f32_16x16x32_bf16 a[116:119], a[244:247], v[60:63], a[116:119]
    v_exp_f32 v32, v88
    v_mfma_f32_16x16x32_bf16 a[88:91], a[248:251], v[56:59], a[88:91]
    s_cbranch_vccnz STUB_E0_0
BACK_E0_0:
    ds_read_b64_tr_b16 a[210:211], v24 offset:4096
    v_exp_f32 v33, v89
    v_mfma_f32_16x16x32_bf16 a[120:123], a[248:251], v[60:63], a[120:123]
    ds_read_b64_tr_b16 a[212:213], v25 offset:0
    v_exp_f32 v34, v90
    v_mfma_f32_16x16x32_bf16 a[92:95], a[252:255], v[56:59], a[92:95]
    ds_read_b64_tr_b16 a[214:215], v25 offset:4096
    v_cvt_pk_bf16_f32 v52, v32, v33
    v_mfma_f32_16x16x32_bf16 a[124:127], a[252:255], v[60:63], a[124:127]
    ds_read_b64_tr_b16 a[216:217], v26 offset:0
    v_exp_f32 v35, v91
    v_mfma_f32_16x16x32_bf16 v[204:207], v[8:11], v[56:59], v[204:207]
    v_exp_f32 v36, v92
    v_mfma_f32_16x16x32_bf16 v[208:211], v[8:11], v[60:63], v[208:211]
    ds_read_b64_tr_b16 a[218:219], v26 offset:4096
    v_cvt_pk_bf16_f32 v53, v34, v35
    s_waitcnt lgkmcnt(14)
    v_mfma_f32_16x16x32_bf16 v[80:83], a[160:163], v[112:115], v[64:67]
    ds_read_b64_tr_b16 a[220:221], v27 offset:0
    v_exp_f32 v37, v93
    v_mfma_f32_16x16x32_bf16 v[80:83], a[164:167], v[116:119], v[80:83]
    ds_read_b64_tr_b16 a[222:223], v27 offset:4096
    v_exp_f32 v38, v94
    v_mfma_f32_16x16x32_bf16 v[80:83], a[168:171], v[120:123], v[80:83]
    s_waitcnt vmcnt(7)
    s_barrier
    v_cvt_pk_bf16_f32 v54, v36, v37
    v_exp_f32 v39, v95
    v_mfma_f32_16x16x32_bf16 v[80:83], a[172:175], v[124:127], v[80:83]
    ds_read_b128 a[128:131], v16 offset:16384
    v_or3_b32 v13, v52, v53, v54
    v_mfma_f32_16x16x32_bf16 v[84:87], a[176:179], v[112:115], v[64:67]
    ds_read_b128 a[132:135], v17 offset:16384
    v_cvt_pk_bf16_f32 v55, v38, v39
    v_mfma_f32_16x16x32_bf16 v[84:87], a[180:183], v[116:119], v[84:87]
    ds_read_b128 a[136:139], v18 offset:16384
    v_bitop3_b32 v13, v13, v55, s48 bitop3:0xa8
    v_mfma_f32_16x16x32_bf16 v[84:87], a[184:187], v[120:123], v[84:87]
    ds_read_b128 a[140:143], v19 offset:16384
    v_cmp_ne_u32 vcc, 0, v13
    v_mfma_f32_16x16x32_bf16 v[84:87], a[188:191], v[124:127], v[84:87]
    v_exp_f32 v32, v80
    s_waitcnt lgkmcnt(4)
    v_mfma_f32_16x16x32_bf16 a[0:3], a[192:195], v[48:51], a[0:3]
    s_cbranch_vccnz STUB_E1_0
BACK_E1_0:
    v_exp_f32 v33, v81
    v_mfma_f32_16x16x32_bf16 a[4:7], a[196:199], v[48:51], a[4:7]
    v_exp_f32 v34, v82
    v_mfma_f32_16x16x32_bf16 a[8:11], a[200:203], v[48:51], a[8:11]
    ds_read_b128 a[144:147], v16 offset:20480
    v_mfma_f32_16x16x32_bf16 a[12:15], a[204:207], v[48:51], a[12:15]
    ds_read_b128 a[148:151], v17 offset:20480
    v_mfma_f32_16x16x32_bf16 a[16:19], a[208:211], v[48:51], a[16:19]
    ds_read_b128 a[152:155], v18 offset:20480
    v_mfma_f32_16x16x32_bf16 a[20:23], a[212:215], v[48:51], a[20:23]
    ds_read_b128 a[156:159], v19 offset:20480
    v_mfma_f32_16x16x32_bf16 a[24:27], a[216:219], v[48:51], a[24:27]
    ds_read_b64_tr_b16 a[224:225], v20 offset:8192
    v_mfma_f32_16x16x32_bf16 a[28:31], a[220:223], v[48:51], a[28:31]
    ds_read_b64_tr_b16 a[226:227], v20 offset:12288
    v_mfma_f32_16x16x32_bf16 v[196:199], v[8:11], v[48:51], v[196:199]
    ds_read_b64_tr_b16 a[228:229], v21 offset:8192
    v_cvt_pk_bf16_f32 v48, v32, v33
    v_mfma_f32_16x16x32_bf16 v[88:91], a[160:163], v[128:131], v[68:71]
    v_exp_f32 v35, v83
    v_mfma_f32_16x16x32_bf16 v[88:91], a[164:167], v[132:135], v[88:91]
    v_exp_f32 v36, v84
    v_mfma_f32_16x16x32_bf16 v[88:91], a[168:171], v[136:139], v[88:91]
    ds_read_b64_tr_b16 a[230:231], v21 offset:12288
    v_cvt_pk_bf16_f32 v49, v34, v35
    v_mfma_f32_16x16x32_bf16 v[88:91], a[172:175], v[140:143], v[88:91]
    v_exp_f32 v37, v85
    v_mfma_f32_16x16x32_bf16 v[92:95], a[176:179], v[128:131], v[68:71]
    ds_read_b64_tr_b16 a[232:233], v22 offset:8192
    v_exp_f32 v38, v86
    v_mfma_f32_16x16x32_bf16 v[92:95], a[180:183], v[132:135], v[92:95]
    ds_read_b64_tr_b16 a[234:235], v22 offset:12288
    v_cvt_pk_bf16_f32 v50, v36, v37
    v_mfma_f32_16x16x32_bf16 v[92:95], a[184:187], v[136:139], v[92:95]
    v_exp_f32 v39, v87
    v_mfma_f32_16x16x32_bf16 v[92:95], a[188:191], v[140:143], v[92:95]
    ds_read_b64_tr_b16 a[236:237], v23 offset:8192
    v_or3_b32 v12, v48, v49, v50
    v_mfma_f32_16x16x32_bf16 a[32:35], a[192:195], v[52:55], a[32:35]
    ds_read_b64_tr_b16 a[238:239], v23 offset:12288
    v_cvt_pk_bf16_f32 v51, v38, v39
    v_mfma_f32_16x16x32_bf16 a[36:39], a[196:199], v[52:55], a[36:39]
    ds_read_b64_tr_b16 a[240:241], v24 offset:8192
    v_bitop3_b32 v12, v12, v51, s48 bitop3:0xa8
    v_mfma_f32_16x16x32_bf16 a[40:43], a[200:203], v[52:55], a[40:43]
    ds_read_b64_tr_b16 a[242:243], v24 offset:12288
    v_cmp_ne_u32 vcc, 0, v12
    v_mfma_f32_16x16x32_bf16 a[44:47], a[204:207], v[52:55], a[44:47]
    v_exp_f32 v32, v88
    v_mfma_f32_16x16x32_bf16 a[48:51], a[208:211], v[52:55], a[48:51]
    s_cbranch_vccnz STUB_E0_1
BACK_E0_1:
    ds_read_b64_tr_b16 a[244:245], v25 offset:8192
    v_exp_f32 v33, v89
    v_mfma_f32_16x16x32_bf16 a[52:55], a[212:215], v[52:55], a[52:55]
    ds_read_b64_tr_b16 a[246:247], v25 offset:12288
    v_exp_f32 v34, v90
    v_mfma_f32_16x16x32_bf16 a[56:59], a[216:219], v[52:55], a[56:59]
    ds_read_b64_tr_b16 a[248:249], v26 offset:8192
    v_mfma_f32_16x16x32_bf16 a[60:63], a[220:223], v[52:55], a[60:63]
    ds_read_b64_tr_b16 a[250:251], v26 offset:12288
    v_mfma_f32_16x16x32_bf16 v[200:203], v[8:11], v[52:55], v[200:203]
    ds_read_b64_tr_b16 a[252:253], v27 offset:8192
    v_cvt_pk_bf16_f32 v52, v32, v33
    s_waitcnt lgkmcnt(15)
    v_mfma_f32_16x16x32_bf16 v[80:83], a[128:131], v[112:115], v[64:67]
    v_exp_f32 v35, v91
    v_mfma_f32_16x16x32_bf16 v[80:83], a[132:135], v[116:119], v[80:83]
    ds_read_b64_tr_b16 a[254:255], v27 offset:12288
    v_exp_f32 v36, v92
    v_mfma_f32_16x16x32_bf16 v[80:83], a[136:139], v[120:123], v[80:83]
    s_waitcnt vmcnt(3)
    s_barrier
    v_cvt_pk_bf16_f32 v53, v34, v35
    v_exp_f32 v37, v93
    v_mfma_f32_16x16x32_bf16 v[80:83], a[140:143], v[124:127], v[80:83]
    v_exp_f32 v38, v94
    v_mfma_f32_16x16x32_bf16 v[84:87], a[144:147], v[112:115], v[64:67]
    ds_read_b128 a[160:163], v16 offset:24576
    v_cvt_pk_bf16_f32 v54, v36, v37
    v_mfma_f32_16x16x32_bf16 v[84:87], a[148:151], v[116:119], v[84:87]
    v_exp_f32 v39, v95
    v_mfma_f32_16x16x32_bf16 v[84:87], a[152:155], v[120:123], v[84:87]
    ds_read_b128 a[164:167], v17 offset:24576
    v_or3_b32 v13, v52, v53, v54
    v_mfma_f32_16x16x32_bf16 v[84:87], a[156:159], v[124:127], v[84:87]
    ds_read_b128 a[168:171], v18 offset:24576
    v_cvt_pk_bf16_f32 v55, v38, v39
    s_waitcnt lgkmcnt(3)
    v_mfma_f32_16x16x32_bf16 a[0:3], a[224:227], v[48:51], a[0:3]
    ds_read_b128 a[172:175], v19 offset:24576
    v_bitop3_b32 v13, v13, v55, s48 bitop3:0xa8
    v_mfma_f32_16x16x32_bf16 a[4:7], a[228:231], v[48:51], a[4:7]
    ds_read_b128 a[176:179], v16 offset:28672
    v_cmp_ne_u32 vcc, 0, v13
    v_mfma_f32_16x16x32_bf16 a[8:11], a[232:235], v[48:51], a[8:11]
    v_exp_f32 v32, v80
    v_mfma_f32_16x16x32_bf16 a[12:15], a[236:239], v[48:51], a[12:15]
    s_cbranch_vccnz STUB_E1_1
BACK_E1_1:
    v_exp_f32 v33, v81
    v_mfma_f32_16x16x32_bf16 a[16:19], a[240:243], v[48:51], a[16:19]
    v_exp_f32 v34, v82
    v_mfma_f32_16x16x32_bf16 a[20:23], a[244:247], v[48:51], a[20:23]
    ds_read_b128 a[180:183], v17 offset:28672
    v_mfma_f32_16x16x32_bf16 a[24:27], a[248:251], v[48:51], a[24:27]
    ds_read_b128 a[184:187], v18 offset:28672
    v_mfma_f32_16x16x32_bf16 a[28:31], a[252:255], v[48:51], a[28:31]
    ds_read_b128 a[188:191], v19 offset:28672
    v_mfma_f32_16x16x32_bf16 v[196:199], v[8:11], v[48:51], v[196:199]
    ds_read_b64_tr_b16 a[192:193], v20 offset:16384
    v_cvt_pk_bf16_f32 v48, v32, v33
    v_mfma_f32_16x16x32_bf16 v[88:91], a[128:131], v[128:131], v[68:71]
    v_exp_f32 v35, v83
    v_mfma_f32_16x16x32_bf16 v[88:91], a[132:135], v[132:135], v[88:91]
    ds_read_b64_tr_b16 a[194:195], v20 offset:20480
    v_exp_f32 v36, v84
    v_mfma_f32_16x16x32_bf16 v[88:91], a[136:139], v[136:139], v[88:91]
    ds_read_b64_tr_b16 a[196:197], v21 offset:16384
    v_cvt_pk_bf16_f32 v49, v34, v35
    v_mfma_f32_16x16x32_bf16 v[88:91], a[140:143], v[140:143], v[88:91]
    ds_read_b64_tr_b16 a[198:199], v21 offset:20480
    v_exp_f32 v37, v85
    v_mfma_f32_16x16x32_bf16 v[92:95], a[144:147], v[128:131], v[68:71]
    ds_read_b64_tr_b16 a[200:201], v22 offset:16384
    v_exp_f32 v38, v86
    v_mfma_f32_16x16x32_bf16 v[92:95], a[148:151], v[132:135], v[92:95]
    ds_read_b64_tr_b16 a[202:203], v22 offset:20480
    v_cvt_pk_bf16_f32 v50, v36, v37
    v_mfma_f32_16x16x32_bf16 v[92:95], a[152:155], v[136:139], v[92:95]
    v_exp_f32 v39, v87
    v_mfma_f32_16x16x32_bf16 v[92:95], a[156:159], v[140:143], v[92:95]
    ds_read_b64_tr_b16 a[204:205], v23 offset:16384
    v_or3_b32 v12, v48, v49, v50
    v_mfma_f32_16x16x32_bf16 a[32:35], a[224:227], v[52:55], a[32:35]
    ds_read_b64_tr_b16 a[206:207], v23 offset:20480
    v_cvt_pk_bf16_f32 v51, v38, v39
    v_mfma_f32_16x16x32_bf16 a[36:39], a[228:231], v[52:55], a[36:39]
    ds_read_b64_tr_b16 a[208:209], v24 offset:16384
    v_bitop3_b32 v12, v12, v51, s48 bitop3:0xa8
    v_mfma_f32_16x16x32_bf16 a[40:43], a[232:235], v[52:55], a[40:43]
    ds_read_b64_tr_b16 a[210:211], v24 offset:20480
    v_cmp_ne_u32 vcc, 0, v12
    v_mfma_f32_16x16x32_bf16 a[44:47], a[236:239], v[52:55], a[44:47]
    v_exp_f32 v32, v88
    v_mfma_f32_16x16x32_bf16 a[48:51], a[240:243], v[52:55], a[48:51]
    s_cbranch_vccnz STUB_E0_2
BACK_E0_2:
    ds_read_b64_tr_b16 a[212:213], v25 offset:16384
    v_exp_f32 v33, v89
    v_mfma_f32_16x16x32_bf16 a[52:55], a[244:247], v[52:55], a[52:55]
    ds_read_b64_tr_b16 a[214:215], v25 offset:20480
    v_exp_f32 v34, v90
    v_mfma_f32_16x16x32_bf16 a[56:59], a[248:251], v[52:55], a[56:59]
    ds_read_b64_tr_b16 a[216:217], v26 offset:16384
    v_mfma_f32_16x16x32_bf16 a[60:63], a[252:255], v[52:55], a[60:63]
    ds_read_b64_tr_b16 a[218:219], v26 offset:20480
    v_mfma_f32_16x16x32_bf16 v[200:203], v[8:11], v[52:55], v[200:203]
    ds_read_b64_tr_b16 a[220:221], v27 offset:16384
    v_cvt_pk_bf16_f32 v52, v32, v33
    s_waitcnt lgkmcnt(15)
    v_mfma_f32_16x16x32_bf16 v[80:83], a[160:163], v[112:115], v[64:67]
    v_exp_f32 v35, v91
    v_mfma_f32_16x16x32_bf16 v[80:83], a[164:167], v[116:119], v[80:83]
    ds_read_b64_tr_b16 a[222:223], v27 offset:20480
    v_exp_f32 v36, v92
    v_mfma_f32_16x16x32_bf16 v[80:83], a[168:171], v[120:123], v[80:83]
    s_waitcnt vmcnt(1)
    s_barrier
    v_cvt_pk_bf16_f32 v53, v34, v35
    v_exp_f32 v37, v93
    v_mfma_f32_16x16x32_bf16 v[80:83], a[172:175], v[124:127], v[80:83]
    v_exp_f32 v38, v94
    v_mfma_f32_16x16x32_bf16 v[84:87], a[176:179], v[112:115], v[64:67]
    ds_read_b64_tr_b16 a[224:225], v20 offset:24576
    v_cvt_pk_bf16_f32 v54, v36, v37
    v_mfma_f32_16x16x32_bf16 v[84:87], a[180:183], v[116:119], v[84:87]
    v_exp_f32 v39, v95
    v_mfma_f32_16x16x32_bf16 v[84:87], a[184:187], v[120:123], v[84:87]
    ds_read_b64_tr_b16 a[226:227], v20 offset:28672
    v_or3_b32 v13, v52, v53, v54
    v_mfma_f32_16x16x32_bf16 v[84:87], a[188:191], v[124:127], v[84:87]
    ds_read_b64_tr_b16 a[228:229], v21 offset:24576
    v_cvt_pk_bf16_f32 v55, v38, v39
    s_waitcnt lgkmcnt(3)
    v_mfma_f32_16x16x32_bf16 a[0:3], a[192:195], v[48:51], a[0:3]
    ds_read_b64_tr_b16 a[230:231], v21 offset:28672
    v_bitop3_b32 v13, v13, v55, s48 bitop3:0xa8
    v_mfma_f32_16x16x32_bf16 a[4:7], a[196:199], v[48:51], a[4:7]
    ds_read_b64_tr_b16 a[232:233], v22 offset:24576
    v_cmp_ne_u32 vcc, 0, v13
    v_mfma_f32_16x16x32_bf16 a[8:11], a[200:203], v[48:51], a[8:11]
    v_exp_f32 v32, v80
    v_mfma_f32_16x16x32_bf16 a[12:15], a[204:207], v[48:51], a[12:15]
    s_cbranch_vccnz STUB_E1_2
BACK_E1_2:
    v_exp_f32 v33, v81
    v_mfma_f32_16x16x32_bf16 a[16:19], a[208:211], v[48:51], a[16:19]
    v_exp_f32 v34, v82
    v_mfma_f32_16x16x32_bf16 a[20:23], a[212:215], v[48:51], a[20:23]
    ds_read_b64_tr_b16 a[234:235], v22 offset:28672
    v_mfma_f32_16x16x32_bf16 a[24:27], a[216:219], v[48:51], a[24:27]
    ds_read_b64_tr_b16 a[236:237], v23 offset:24576
    v_mfma_f32_16x16x32_bf16 a[28:31], a[220:223], v[48:51], a[28:31]
    ds_read_b64_tr_b16 a[238:239], v23 offset:28672
    v_mfma_f32_16x16x32_bf16 v[196:199], v[8:11], v[48:51], v[196:199]
    ds_read_b64_tr_b16 a[240:241], v24 offset:24576
    v_cvt_pk_bf16_f32 v48, v32, v33
    v_mfma_f32_16x16x32_bf16 v[88:91], a[160:163], v[128:131], v[68:71]
    v_exp_f32 v35, v83
    v_mfma_f32_16x16x32_bf16 v[88:91], a[164:167], v[132:135], v[88:91]
    v_exp_f32 v36, v84
    v_mfma_f32_16x16x32_bf16 v[88:91], a[168:171], v[136:139], v[88:91]
    ds_read_b64_tr_b16 a[242:243], v24 offset:28672
    v_cvt_pk_bf16_f32 v49, v34, v35
    v_mfma_f32_16x16x32_bf16 v[88:91], a[172:175], v[140:143], v[88:91]
    v_exp_f32 v37, v85
    v_mfma_f32_16x16x32_bf16 v[92:95], a[176:179], v[128:131], v[68:71]
    v_exp_f32 v38, v86
    v_mfma_f32_16x16x32_bf16 v[92:95], a[180:183], v[132:135], v[92:95]
    ds_read_b64_tr_b16 a[244:245], v25 offset:24576
    v_cvt_pk_bf16_f32 v50, v36, v37
    v_mfma_f32_16x16x32_bf16 v[92:95], a[184:187], v[136:139], v[92:95]
    v_exp_f32 v39, v87
    v_mfma_f32_16x16x32_bf16 v[92:95], a[188:191], v[140:143], v[92:95]
    ds_read_b64_tr_b16 a[246:247], v25 offset:28672
    v_or3_b32 v12, v48, v49, v50
    v_mfma_f32_16x16x32_bf16 a[32:35], a[192:195], v[52:55], a[32:35]
    ds_read_b64_tr_b16 a[248:249], v26 offset:24576
    v_cvt_pk_bf16_f32 v51, v38, v39
    v_mfma_f32_16x16x32_bf16 a[36:39], a[196:199], v[52:55], a[36:39]
    ds_read_b64_tr_b16 a[250:251], v26 offset:28672
    v_bitop3_b32 v12, v12, v51, s48 bitop3:0xa8
    v_mfma_f32_16x16x32_bf16 a[40:43], a[200:203], v[52:55], a[40:43]
    ds_read_b64_tr_b16 a[252:253], v27 offset:24576
    v_cmp_ne_u32 vcc, 0, v12
    v_mfma_f32_16x16x32_bf16 a[44:47], a[204:207], v[52:55], a[44:47]
    v_exp_f32 v32, v88
    v_mfma_f32_16x16x32_bf16 a[48:51], a[208:211], v[52:55], a[48:51]
    s_cbranch_vccnz STUB_E0_3
BACK_E0_3:
    v_exp_f32 v33, v89
    v_mfma_f32_16x16x32_bf16 a[52:55], a[212:215], v[52:55], a[52:55]
    v_exp_f32 v34, v90
    v_mfma_f32_16x16x32_bf16 a[56:59], a[216:219], v[52:55], a[56:59]
    ds_read_b64_tr_b16 a[254:255], v27 offset:28672
    v_mfma_f32_16x16x32_bf16 a[60:63], a[220:223], v[52:55], a[60:63]
    v_mfma_f32_16x16x32_bf16 v[200:203], v[8:11], v[52:55], v[200:203]
    v_cvt_pk_bf16_f32 v52, v32, v33
    v_exp_f32 v35, v91
    v_mfma_f32_16x16x32_bf16 v[96:99], a[128:131], v[144:147], v[72:75]
    v_exp_f32 v36, v92
    v_mfma_f32_16x16x32_bf16 v[96:99], a[132:135], v[148:151], v[96:99]
    v_cvt_pk_bf16_f32 v53, v34, v35
    v_exp_f32 v37, v93
    v_mfma_f32_16x16x32_bf16 v[96:99], a[136:139], v[152:155], v[96:99]
    v_exp_f32 v38, v94
    v_mfma_f32_16x16x32_bf16 v[96:99], a[140:143], v[156:159], v[96:99]
    v_cvt_pk_bf16_f32 v54, v36, v37
    v_exp_f32 v39, v95
    v_mfma_f32_16x16x32_bf16 v[100:103], a[144:147], v[144:147], v[72:75]
    v_or3_b32 v13, v52, v53, v54
    v_cvt_pk_bf16_f32 v55, v38, v39
    v_mfma_f32_16x16x32_bf16 v[100:103], a[148:151], v[148:151], v[100:103]
    v_bitop3_b32 v13, v13, v55, s48 bitop3:0xa8
    v_cmp_ne_u32 vcc, 0, v13
    v_mfma_f32_16x16x32_bf16 v[100:103], a[152:155], v[152:155], v[100:103]
    v_exp_f32 v32, v96
    v_mfma_f32_16x16x32_bf16 v[100:103], a[156:159], v[156:159], v[100:103]
    s_cbranch_vccnz STUB_E1_3
BACK_E1_3:
    v_exp_f32 v33, v97
    s_waitcnt lgkmcnt(0)
    v_mfma_f32_16x16x32_bf16 a[0:3], a[224:227], v[48:51], a[0:3]
    v_exp_f32 v34, v98
    v_mfma_f32_16x16x32_bf16 a[4:7], a[228:231], v[48:51], a[4:7]
    v_cvt_pk_bf16_f32 v56, v32, v33
    v_exp_f32 v35, v99
    v_mfma_f32_16x16x32_bf16 a[8:11], a[232:235], v[48:51], a[8:11]
    v_exp_f32 v36, v100
    v_mfma_f32_16x16x32_bf16 a[12:15], a[236:239], v[48:51], a[12:15]
    v_cvt_pk_bf16_f32 v57, v34, v35
    v_exp_f32 v37, v101
    v_mfma_f32_16x16x32_bf16 a[16:19], a[240:243], v[48:51], a[16:19]
    v_exp_f32 v38, v102
    v_mfma_f32_16x16x32_bf16 a[20:23], a[244:247], v[48:51], a[20:23]
    v_cvt_pk_bf16_f32 v58, v36, v37
    v_exp_f32 v39, v103
    v_mfma_f32_16x16x32_bf16 a[24:27], a[248:251], v[48:51], a[24:27]
    v_or3_b32 v12, v56, v57, v58
    v_cvt_pk_bf16_f32 v59, v38, v39
    v_mfma_f32_16x16x32_bf16 a[28:31], a[252:255], v[48:51], a[28:31]
    v_bitop3_b32 v12, v12, v59, s48 bitop3:0xa8
    v_cmp_ne_u32 vcc, 0, v12
    v_mfma_f32_16x16x32_bf16 v[196:199], v[8:11], v[48:51], v[196:199]
    v_mfma_f32_16x16x32_bf16 v[104:107], a[128:131], v[160:163], v[76:79]
    s_cbranch_vccnz STUB_E2_4
BACK_E2_4:
    v_mfma_f32_16x16x32_bf16 v[104:107], a[132:135], v[164:167], v[104:107]
    v_mfma_f32_16x16x32_bf16 v[104:107], a[136:139], v[168:171], v[104:107]
    v_mfma_f32_16x16x32_bf16 v[104:107], a[140:143], v[172:175], v[104:107]
    v_mfma_f32_16x16x32_bf16 v[108:111], a[144:147], v[160:163], v[76:79]
    v_mfma_f32_16x16x32_bf16 v[108:111], a[148:151], v[164:167], v[108:111]
    v_mfma_f32_16x16x32_bf16 v[108:111], a[152:155], v[168:171], v[108:111]
    v_accvgpr_read_b32 v224, a0
    v_accvgpr_read_b32 v225, a1
    v_mfma_f32_16x16x32_bf16 v[108:111], a[156:159], v[172:175], v[108:111]
    v_cvt_pk_bf16_f32 v112, v224, v225
    v_accvgpr_read_b32 v226, a2
    v_mfma_f32_16x16x32_bf16 a[32:35], a[224:227], v[52:55], a[32:35]
    v_exp_f32 v32, v104
    v_accvgpr_read_b32 v227, a3
    v_cvt_pk_bf16_f32 v113, v226, v227
    v_mfma_f32_16x16x32_bf16 a[36:39], a[228:231], v[52:55], a[36:39]
    v_exp_f32 v33, v105
    v_accvgpr_read_b32 v224, a4
    v_accvgpr_read_b32 v225, a5
    v_mfma_f32_16x16x32_bf16 a[40:43], a[232:235], v[52:55], a[40:43]
    v_exp_f32 v34, v106
    v_cvt_pk_bf16_f32 v114, v224, v225
    v_accvgpr_read_b32 v226, a6
    v_mfma_f32_16x16x32_bf16 a[44:47], a[236:239], v[52:55], a[44:47]
    ds_read_b128 a[128:131], v16 offset:0
    v_cvt_pk_bf16_f32 v60, v32, v33
    v_accvgpr_read_b32 v227, a7
    v_cvt_pk_bf16_f32 v115, v226, v227
    v_mfma_f32_16x16x32_bf16 a[48:51], a[240:243], v[52:55], a[48:51]
    v_exp_f32 v35, v107
    buffer_store_dwordx4 v[112:115], v46, s[40:43], s58 offen offset:0 sc1
    v_accvgpr_read_b32 v224, a8
    v_mfma_f32_16x16x32_bf16 a[52:55], a[244:247], v[52:55], a[52:55]
    v_exp_f32 v36, v108
    v_accvgpr_read_b32 v225, a9
    v_cvt_pk_bf16_f32 v116, v224, v225
    v_mfma_f32_16x16x32_bf16 a[56:59], a[248:251], v[52:55], a[56:59]
    ds_read_b128 a[132:135], v17 offset:0
    v_cvt_pk_bf16_f32 v61, v34, v35
    v_accvgpr_read_b32 v226, a10
    v_accvgpr_read_b32 v227, a11
    v_mfma_f32_16x16x32_bf16 a[60:63], a[252:255], v[52:55], a[60:63]
    v_exp_f32 v37, v109
    v_cvt_pk_bf16_f32 v117, v226, v227
    v_accvgpr_read_b32 v224, a12
    v_mfma_f32_16x16x32_bf16 v[200:203], v[8:11], v[52:55], v[200:203]
    v_exp_f32 v38, v110
    v_accvgpr_read_b32 v225, a13
    v_cvt_pk_bf16_f32 v118, v224, v225
    v_mfma_f32_16x16x32_bf16 v[96:99], a[160:163], v[144:147], v[72:75]
    ds_read_b128 a[136:139], v18 offset:0
    v_cvt_pk_bf16_f32 v62, v36, v37
    v_accvgpr_read_b32 v226, a14
    v_accvgpr_read_b32 v227, a15
    v_mfma_f32_16x16x32_bf16 v[96:99], a[164:167], v[148:151], v[96:99]
    v_exp_f32 v39, v111
    v_cvt_pk_bf16_f32 v119, v226, v227
    buffer_store_dwordx4 v[116:119], v46, s[40:43], s58 offen offset:1024 sc1
    v_mfma_f32_16x16x32_bf16 v[96:99], a[168:171], v[152:155], v[96:99]
    ds_read_b128 a[140:143], v19 offset:0
    v_or3_b32 v13, v60, v61, v62
    v_accvgpr_read_b32 v224, a16
    v_accvgpr_read_b32 v225, a17
    v_mfma_f32_16x16x32_bf16 v[96:99], a[172:175], v[156:159], v[96:99]
    ds_read_b128 a[144:147], v16 offset:4096
    v_cvt_pk_bf16_f32 v63, v38, v39
    v_cvt_pk_bf16_f32 v120, v224, v225
    v_accvgpr_read_b32 v226, a18
    v_mfma_f32_16x16x32_bf16 v[100:103], a[176:179], v[144:147], v[72:75]
    ds_read_b128 a[148:151], v17 offset:4096
    v_bitop3_b32 v13, v13, v63, s48 bitop3:0xa8
    v_accvgpr_read_b32 v227, a19
    v_cvt_pk_bf16_f32 v121, v226, v227
    v_mfma_f32_16x16x32_bf16 v[100:103], a[180:183], v[148:151], v[100:103]
    ds_read_b128 a[152:155], v18 offset:4096
    v_cmp_ne_u32 vcc, 0, v13
    v_accvgpr_read_b32 v224, a20
    v_accvgpr_read_b32 v225, a21
    v_mfma_f32_16x16x32_bf16 v[100:103], a[184:187], v[152:155], v[100:103]
    v_exp_f32 v32, v96
    v_cvt_pk_bf16_f32 v122, v224, v225
    v_accvgpr_read_b32 v226, a22
    v_mfma_f32_16x16x32_bf16 v[100:103], a[188:191], v[156:159], v[100:103]
    s_cbranch_vccnz STUB_E3_4
BACK_E3_4:
    v_exp_f32 v33, v97
    v_accvgpr_read_b32 v227, a23
    v_cvt_pk_bf16_f32 v123, v226, v227
    v_mfma_f32_16x16x32_bf16 a[64:67], a[192:195], v[56:59], a[64:67]
    v_exp_f32 v34, v98
    buffer_store_dwordx4 v[120:123], v46, s[40:43], s59 offen offset:0 sc1
    v_accvgpr_read_b32 v224, a24
    v_mfma_f32_16x16x32_bf16 a[68:71], a[196:199], v[56:59], a[68:71]
    ds_read_b128 a[156:159], v19 offset:4096
    v_accvgpr_read_b32 v225, a25
    v_cvt_pk_bf16_f32 v124, v224, v225
    v_mfma_f32_16x16x32_bf16 a[72:75], a[200:203], v[56:59], a[72:75]
    v_accvgpr_read_b32 v226, a26
    v_accvgpr_read_b32 v227, a27
    v_mfma_f32_16x16x32_bf16 a[76:79], a[204:207], v[56:59], a[76:79]
    v_cvt_pk_bf16_f32 v125, v226, v227
    v_accvgpr_read_b32 v224, a28
    v_mfma_f32_16x16x32_bf16 a[80:83], a[208:211], v[56:59], a[80:83]
    v_accvgpr_read_b32 v225, a29
    v_cvt_pk_bf16_f32 v126, v224, v225
    v_mfma_f32_16x16x32_bf16 a[84:87], a[212:215], v[56:59], a[84:87]
    v_accvgpr_read_b32 v226, a30
    v_accvgpr_read_b32 v227, a31
    v_mfma_f32_16x16x32_bf16 a[88:91], a[216:219], v[56:59], a[88:91]
    v_cvt_pk_bf16_f32 v127, v226, v227
    buffer_store_dwordx4 v[124:127], v46, s[40:43], s59 offen offset:1024 sc1
    v_mfma_f32_16x16x32_bf16 a[92:95], a[220:223], v[56:59], a[92:95]
    v_mov_b32 v232, v64
    v_mov_b32 v233, v196
    v_mfma_f32_16x16x32_bf16 v[204:207], v[8:11], v[56:59], v[204:207]
    v_cvt_pk_bf16_f32 v56, v32, v33
    v_exp_f32 v35, v99
    buffer_store_dwordx2 v[232:233], v47, s[40:43], s68 offen offset:0 sc1
    v_accvgpr_read_b32 v224, a32
    v_mfma_f32_16x16x32_bf16 v[104:107], a[160:163], v[160:163], v[76:79]
    v_exp_f32 v36, v100
    v_accvgpr_read_b32 v225, a33
    v_cvt_pk_bf16_f32 v128, v224, v225
    v_mfma_f32_16x16x32_bf16 v[104:107], a[164:167], v[164:167], v[104:107]
    v_cvt_pk_bf16_f32 v57, v34, v35
    v_exp_f32 v37, v101
    v_accvgpr_read_b32 v226, a34
    v_accvgpr_read_b32 v227, a35
    v_mfma_f32_16x16x32_bf16 v[104:107], a[168:171], v[168:171], v[104:107]
    v_exp_f32 v38, v102
    v_cvt_pk_bf16_f32 v129, v226, v227
    v_accvgpr_read_b32 v224, a36
    v_mfma_f32_16x16x32_bf16 v[104:107], a[172:175], v[172:175], v[104:107]
    v_cvt_pk_bf16_f32 v58, v36, v37
    v_exp_f32 v39, v103
    v_accvgpr_read_b32 v225, a37
    v_cvt_pk_bf16_f32 v130, v224, v225
    v_mfma_f32_16x16x32_bf16 v[108:111], a[176:179], v[160:163], v[76:79]
    v_or3_b32 v12, v56, v57, v58
    v_cvt_pk_bf16_f32 v59, v38, v39
    v_accvgpr_read_b32 v226, a38
    v_accvgpr_read_b32 v227, a39
    v_mfma_f32_16x16x32_bf16 v[108:111], a[180:183], v[164:167], v[108:111]
    v_bitop3_b32 v12, v12, v59, s48 bitop3:0xa8
    v_cmp_ne_u32 vcc, 0, v12
    v_cvt_pk_bf16_f32 v131, v226, v227
    buffer_store_dwordx4 v[128:131], v46, s[40:43], s58 offen offset:2048 sc1
    v_mfma_f32_16x16x32_bf16 v[108:111], a[184:187], v[168:171], v[108:111]
    v_exp_f32 v32, v104
    v_accvgpr_read_b32 v224, a40
    v_accvgpr_read_b32 v225, a41
    v_mfma_f32_16x16x32_bf16 v[108:111], a[188:191], v[172:175], v[108:111]
    s_cbranch_vccnz STUB_E2_5
BACK_E2_5:
    v_exp_f32 v33, v105
    v_cvt_pk_bf16_f32 v132, v224, v225
    v_accvgpr_read_b32 v226, a42
    v_mfma_f32_16x16x32_bf16 a[96:99], a[192:195], v[60:63], a[96:99]
    v_exp_f32 v34, v106
    v_accvgpr_read_b32 v227, a43
    v_cvt_pk_bf16_f32 v133, v226, v227
    v_mfma_f32_16x16x32_bf16 a[100:103], a[196:199], v[60:63], a[100:103]
    v_accvgpr_read_b32 v224, a44
    v_accvgpr_read_b32 v225, a45
    v_mfma_f32_16x16x32_bf16 a[104:107], a[200:203], v[60:63], a[104:107]
    ds_read_b128 a[160:163], v16 offset:8192
    v_cvt_pk_bf16_f32 v134, v224, v225
    v_accvgpr_read_b32 v226, a46
    v_mfma_f32_16x16x32_bf16 a[108:111], a[204:207], v[60:63], a[108:111]
    ds_read_b128 a[164:167], v17 offset:8192
    v_accvgpr_read_b32 v227, a47
    v_cvt_pk_bf16_f32 v135, v226, v227
    v_mfma_f32_16x16x32_bf16 a[112:115], a[208:211], v[60:63], a[112:115]
    ds_read_b128 a[168:171], v18 offset:8192
    buffer_store_dwordx4 v[132:135], v46, s[40:43], s58 offen offset:3072 sc1
    v_accvgpr_read_b32 v224, a48
    v_mfma_f32_16x16x32_bf16 a[116:119], a[212:215], v[60:63], a[116:119]
    ds_read_b128 a[172:175], v19 offset:8192
    v_accvgpr_read_b32 v225, a49
    v_cvt_pk_bf16_f32 v136, v224, v225
    v_mfma_f32_16x16x32_bf16 a[120:123], a[216:219], v[60:63], a[120:123]
    ds_read_b128 a[176:179], v16 offset:12288
    v_accvgpr_read_b32 v226, a50
    v_accvgpr_read_b32 v227, a51
    v_mfma_f32_16x16x32_bf16 a[124:127], a[220:223], v[60:63], a[124:127]
    ds_read_b128 a[180:183], v17 offset:12288
    v_cvt_pk_bf16_f32 v137, v226, v227
    v_accvgpr_read_b32 v224, a52
    v_mfma_f32_16x16x32_bf16 v[208:211], v[8:11], v[60:63], v[208:211]
    ds_read_b128 a[184:187], v18 offset:12288
    v_cvt_pk_bf16_f32 v60, v32, v33
    v_accvgpr_read_b32 v225, a53
    v_cvt_pk_bf16_f32 v138, v224, v225
    s_waitcnt lgkmcnt(7)
    v_mfma_f32_16x16x32_bf16 v[96:99], a[128:131], v[144:147], v[72:75]
    v_exp_f32 v35, v107
    v_accvgpr_read_b32 v226, a54
    v_accvgpr_read_b32 v227, a55
    v_mfma_f32_16x16x32_bf16 v[96:99], a[132:135], v[148:151], v[96:99]
    v_exp_f32 v36, v108
    v_cvt_pk_bf16_f32 v139, v226, v227
    buffer_store_dwordx4 v[136:139], v46, s[40:43], s59 offen offset:2048 sc1
    v_mfma_f32_16x16x32_bf16 v[96:99], a[136:139], v[152:155], v[96:99]
    ds_read_b128 a[188:191], v19 offset:12288
    v_cvt_pk_bf16_f32 v61, v34, v35
    v_accvgpr_read_b32 v224, a56
    v_accvgpr_read_b32 v225, a57
    v_mfma_f32_16x16x32_bf16 v[96:99], a[140:143], v[156:159], v[96:99]
    v_exp_f32 v37, v109
    v_cvt_pk_bf16_f32 v140, v224, v225
    v_accvgpr_read_b32 v226, a58
    v_mfma_f32_16x16x32_bf16 v[100:103], a[144:147], v[144:147], v[72:75]
    v_exp_f32 v38, v110
    v_accvgpr_read_b32 v227, a59
    v_cvt_pk_bf16_f32 v141, v226, v227
    v_mfma_f32_16x16x32_bf16 v[100:103], a[148:151], v[148:151], v[100:103]
    ds_read_b64_tr_b16 a[192:193], v20 offset:0
    v_cvt_pk_bf16_f32 v62, v36, v37
    v_accvgpr_read_b32 v224, a60
    v_accvgpr_read_b32 v225, a61
    v_mfma_f32_16x16x32_bf16 v[100:103], a[152:155], v[152:155], v[100:103]
    v_exp_f32 v39, v111
    v_cvt_pk_bf16_f32 v142, v224, v225
    v_accvgpr_read_b32 v226, a62
    v_mfma_f32_16x16x32_bf16 v[100:103], a[156:159], v[156:159], v[100:103]
    ds_read_b64_tr_b16 a[194:195], v20 offset:4096
    v_or3_b32 v13, v60, v61, v62
    v_accvgpr_read_b32 v227, a63
    v_cvt_pk_bf16_f32 v143, v226, v227
    v_mfma_f32_16x16x32_bf16 a[64:67], a[224:227], v[56:59], a[64:67]
    ds_read_b64_tr_b16 a[196:197], v21 offset:0
    v_cvt_pk_bf16_f32 v63, v38, v39
    buffer_store_dwordx4 v[140:143], v46, s[40:43], s59 offen offset:3072 sc1
    v_mov_b32 v234, v68
    v_mfma_f32_16x16x32_bf16 a[68:71], a[228:231], v[56:59], a[68:71]
    ds_read_b64_tr_b16 a[198:199], v21 offset:4096
    v_bitop3_b32 v13, v13, v63, s48 bitop3:0xa8
    v_mov_b32 v235, v200
    buffer_store_dwordx2 v[234:235], v47, s[40:43], s68 offen offset:128 sc1
    v_mfma_f32_16x16x32_bf16 a[72:75], a[232:235], v[56:59], a[72:75]
    ds_read_b64_tr_b16 a[200:201], v22 offset:0
    v_cmp_ne_u32 vcc, 0, v13
    v_mfma_f32_16x16x32_bf16 a[76:79], a[236:239], v[56:59], a[76:79]
    v_exp_f32 v32, v96
    v_mfma_f32_16x16x32_bf16 a[80:83], a[240:243], v[56:59], a[80:83]
    s_cbranch_vccnz STUB_E3_5
BACK_E3_5:
    v_exp_f32 v33, v97
    v_mfma_f32_16x16x32_bf16 a[84:87], a[244:247], v[56:59], a[84:87]
    v_exp_f32 v34, v98
    v_mfma_f32_16x16x32_bf16 a[88:91], a[248:251], v[56:59], a[88:91]
    ds_read_b64_tr_b16 a[202:203], v22 offset:4096
    v_mfma_f32_16x16x32_bf16 a[92:95], a[252:255], v[56:59], a[92:95]
    ds_read_b64_tr_b16 a[204:205], v23 offset:0
    v_mfma_f32_16x16x32_bf16 v[204:207], v[8:11], v[56:59], v[204:207]
    ds_read_b64_tr_b16 a[206:207], v23 offset:4096
    v_cvt_pk_bf16_f32 v56, v32, v33
    v_mfma_f32_16x16x32_bf16 v[104:107], a[128:131], v[160:163], v[76:79]
    v_exp_f32 v35, v99
    v_mfma_f32_16x16x32_bf16 v[104:107], a[132:135], v[164:167], v[104:107]
    v_exp_f32 v36, v100
    v_mfma_f32_16x16x32_bf16 v[104:107], a[136:139], v[168:171], v[104:107]
    ds_read_b64_tr_b16 a[208:209], v24 offset:0
    v_cvt_pk_bf16_f32 v57, v34, v35
    v_mfma_f32_16x16x32_bf16 v[104:107], a[140:143], v[172:175], v[104:107]
    v_exp_f32 v37, v101
    v_mfma_f32_16x16x32_bf16 v[108:111], a[144:147], v[160:163], v[76:79]
    v_exp_f32 v38, v102
    v_mfma_f32_16x16x32_bf16 v[108:111], a[148:151], v[164:167], v[108:111]
    ds_read_b64_tr_b16 a[210:211], v24 offset:4096
    v_cvt_pk_bf16_f32 v58, v36, v37
    v_mfma_f32_16x16x32_bf16 v[108:111], a[152:155], v[168:171], v[108:111]
    v_exp_f32 v39, v103
    v_mfma_f32_16x16x32_bf16 v[108:111], a[156:159], v[172:175], v[108:111]
    ds_read_b64_tr_b16 a[212:213], v25 offset:0
    v_or3_b32 v12, v56, v57, v58
    v_mfma_f32_16x16x32_bf16 a[96:99], a[224:227], v[60:63], a[96:99]
    ds_read_b64_tr_b16 a[214:215], v25 offset:4096
    v_cvt_pk_bf16_f32 v59, v38, v39
    v_mfma_f32_16x16x32_bf16 a[100:103], a[228:231], v[60:63], a[100:103]
    ds_read_b64_tr_b16 a[216:217], v26 offset:0
    v_bitop3_b32 v12, v12, v59, s48 bitop3:0xa8
    v_mfma_f32_16x16x32_bf16 a[104:107], a[232:235], v[60:63], a[104:107]
    ds_read_b64_tr_b16 a[218:219], v26 offset:4096
    v_cmp_ne_u32 vcc, 0, v12
    v_mfma_f32_16x16x32_bf16 a[108:111], a[236:239], v[60:63], a[108:111]
    v_exp_f32 v32, v104
    v_mfma_f32_16x16x32_bf16 a[112:115], a[240:243], v[60:63], a[112:115]
    s_cbranch_vccnz STUB_E2_6
BACK_E2_6:
    v_exp_f32 v33, v105
    v_mfma_f32_16x16x32_bf16 a[116:119], a[244:247], v[60:63], a[116:119]
    v_exp_f32 v34, v106
    v_mfma_f32_16x16x32_bf16 a[120:123], a[248:251], v[60:63], a[120:123]
    ds_read_b64_tr_b16 a[220:221], v27 offset:0
    v_mfma_f32_16x16x32_bf16 a[124:127], a[252:255], v[60:63], a[124:127]
    ds_read_b64_tr_b16 a[222:223], v27 offset:4096
    v_mfma_f32_16x16x32_bf16 v[208:211], v[8:11], v[60:63], v[208:211]
    ds_read_b64_tr_b16 a[224:225], v20 offset:8192
    v_cvt_pk_bf16_f32 v60, v32, v33
    s_waitcnt lgkmcnt(15)
    v_mfma_f32_16x16x32_bf16 v[96:99], a[160:163], v[144:147], v[72:75]
    v_exp_f32 v35, v107
    v_mfma_f32_16x16x32_bf16 v[96:99], a[164:167], v[148:151], v[96:99]
    v_exp_f32 v36, v108
    v_mfma_f32_16x16x32_bf16 v[96:99], a[168:171], v[152:155], v[96:99]
    ds_read_b64_tr_b16 a[226:227], v20 offset:12288
    v_cvt_pk_bf16_f32 v61, v34, v35
    v_mfma_f32_16x16x32_bf16 v[96:99], a[172:175], v[156:159], v[96:99]
    v_exp_f32 v37, v109
    v_mfma_f32_16x16x32_bf16 v[100:103], a[176:179], v[144:147], v[72:75]
    v_exp_f32 v38, v110
    v_mfma_f32_16x16x32_bf16 v[100:103], a[180:183], v[148:151], v[100:103]
    ds_read_b64_tr_b16 a[228:229], v21 offset:8192
    v_cvt_pk_bf16_f32 v62, v36, v37
    v_mfma_f32_16x16x32_bf16 v[100:103], a[184:187], v[152:155], v[100:103]
    v_exp_f32 v39, v111
    v_mfma_f32_16x16x32_bf16 v[100:103], a[188:191], v[156:159], v[100:103]
    ds_read_b64_tr_b16 a[230:231], v21 offset:12288
    v_or3_b32 v13, v60, v61, v62
    s_waitcnt lgkmcnt(4)
    v_mfma_f32_16x16x32_bf16 a[64:67], a[192:195], v[56:59], a[64:67]
    ds_read_b64_tr_b16 a[232:233], v22 offset:8192
    v_cvt_pk_bf16_f32 v63, v38, v39
    v_mfma_f32_16x16x32_bf16 a[68:71], a[196:199], v[56:59], a[68:71]
    ds_read_b64_tr_b16 a[234:235], v22 offset:12288
    v_bitop3_b32 v13, v13, v63, s48 bitop3:0xa8
    v_mfma_f32_16x16x32_bf16 a[72:75], a[200:203], v[56:59], a[72:75]
    ds_read_b64_tr_b16 a[236:237], v23 offset:8192
    v_cmp_ne_u32 vcc, 0, v13
    v_mfma_f32_16x16x32_bf16 a[76:79], a[204:207], v[56:59], a[76:79]
    v_exp_f32 v32, v96
    v_mfma_f32_16x16x32_bf16 a[80:83], a[208:211], v[56:59], a[80:83]
    s_cbranch_vccnz STUB_E3_6
BACK_E3_6:
    v_exp_f32 v33, v97
    v_mfma_f32_16x16x32_bf16 a[84:87], a[212:215], v[56:59], a[84:87]
    v_exp_f32 v34, v98
    v_mfma_f32_16x16x32_bf16 a[88:91], a[216:219], v[56:59], a[88:91]
    ds_read_b64_tr_b16 a[238:239], v23 offset:12288
    v_mfma_f32_16x16x32_bf16 a[92:95], a[220:223], v[56:59], a[92:95]
    ds_read_b64_tr_b16 a[240:241], v24 offset:8192
    v_mfma_f32_16x16x32_bf16 v[204:207], v[8:11], v[56:59], v[204:207]
    ds_read_b64_tr_b16 a[242:243], v24 offset:12288
    v_cvt_pk_bf16_f32 v56, v32, v33
    v_mfma_f32_16x16x32_bf16 v[104:107], a[160:163], v[160:163], v[76:79]
    v_exp_f32 v35, v99
    v_mfma_f32_16x16x32_bf16 v[104:107], a[164:167], v[164:167], v[104:107]
    v_exp_f32 v36, v100
    v_mfma_f32_16x16x32_bf16 v[104:107], a[168:171], v[168:171], v[104:107]
    ds_read_b64_tr_b16 a[244:245], v25 offset:8192
    v_cvt_pk_bf16_f32 v57, v34, v35
    v_mfma_f32_16x16x32_bf16 v[104:107], a[172:175], v[172:175], v[104:107]
    v_exp_f32 v37, v101
    v_mfma_f32_16x16x32_bf16 v[108:111], a[176:179], v[160:163], v[76:79]
    v_exp_f32 v38, v102
    v_mfma_f32_16x16x32_bf16 v[108:111], a[180:183], v[164:167], v[108:111]
    ds_read_b64_tr_b16 a[246:247], v25 offset:12288
    v_cvt_pk_bf16_f32 v58, v36, v37
    v_mfma_f32_16x16x32_bf16 v[108:111], a[184:187], v[168:171], v[108:111]
    ds_read_b64_tr_b16 a[248:249], v26 offset:8192
    v_exp_f32 v39, v103
    v_mfma_f32_16x16x32_bf16 v[108:111], a[188:191], v[172:175], v[108:111]
    ds_read_b64_tr_b16 a[250:251], v26 offset:12288
    v_or3_b32 v12, v56, v57, v58
    v_mfma_f32_16x16x32_bf16 a[96:99], a[192:195], v[60:63], a[96:99]
    ds_read_b64_tr_b16 a[252:253], v27 offset:8192
    v_cvt_pk_bf16_f32 v59, v38, v39
    v_mfma_f32_16x16x32_bf16 a[100:103], a[196:199], v[60:63], a[100:103]
    ds_read_b64_tr_b16 a[254:255], v27 offset:12288
    v_bitop3_b32 v12, v12, v59, s48 bitop3:0xa8
    v_mfma_f32_16x16x32_bf16 a[104:107], a[200:203], v[60:63], a[104:107]
    v_cmp_ne_u32 vcc, 0, v12
    v_exp_f32 v32, v104
    v_mfma_f32_16x16x32_bf16 a[108:111], a[204:207], v[60:63], a[108:111]
    v_exp_f32 v33, v105
    v_mfma_f32_16x16x32_bf16 a[112:115], a[208:211], v[60:63], a[112:115]
    s_cbranch_vccnz STUB_E2_7
BACK_E2_7:
    v_exp_f32 v34, v106
    v_mfma_f32_16x16x32_bf16 a[116:119], a[212:215], v[60:63], a[116:119]
    v_mfma_f32_16x16x32_bf16 a[120:123], a[216:219], v[60:63], a[120:123]
    v_mfma_f32_16x16x32_bf16 a[124:127], a[220:223], v[60:63], a[124:127]
    v_mfma_f32_16x16x32_bf16 v[208:211], v[8:11], v[60:63], v[208:211]
    v_cvt_pk_bf16_f32 v60, v32, v33
    v_exp_f32 v35, v107
    s_waitcnt lgkmcnt(0)
    v_mfma_f32_16x16x32_bf16 a[64:67], a[224:227], v[56:59], a[64:67]
    v_exp_f32 v36, v108
    v_mfma_f32_16x16x32_bf16 a[68:71], a[228:231], v[56:59], a[68:71]
    v_cvt_pk_bf16_f32 v61, v34, v35
    v_exp_f32 v37, v109
    v_mfma_f32_16x16x32_bf16 a[72:75], a[232:235], v[56:59], a[72:75]
    v_exp_f32 v38, v110
    v_mfma_f32_16x16x32_bf16 a[76:79], a[236:239], v[56:59], a[76:79]
    v_cvt_pk_bf16_f32 v62, v36, v37
    v_exp_f32 v39, v111
    v_mfma_f32_16x16x32_bf16 a[80:83], a[240:243], v[56:59], a[80:83]
    v_or3_b32 v13, v60, v61, v62
    v_cvt_pk_bf16_f32 v63, v38, v39
    v_mfma_f32_16x16x32_bf16 a[84:87], a[244:247], v[56:59], a[84:87]
    v_bitop3_b32 v13, v13, v63, s48 bitop3:0xa8
    v_cmp_ne_u32 vcc, 0, v13
    v_mfma_f32_16x16x32_bf16 a[88:91], a[248:251], v[56:59], a[88:91]
    v_mfma_f32_16x16x32_bf16 a[92:95], a[252:255], v[56:59], a[92:95]
    s_cbranch_vccnz STUB_E3_7
BACK_E3_7:
    v_mfma_f32_16x16x32_bf16 v[204:207], v[8:11], v[56:59], v[204:207]
    v_mfma_f32_16x16x32_bf16 a[96:99], a[224:227], v[60:63], a[96:99]
    v_mfma_f32_16x16x32_bf16 a[100:103], a[228:231], v[60:63], a[100:103]
    v_mfma_f32_16x16x32_bf16 a[104:107], a[232:235], v[60:63], a[104:107]
    v_mfma_f32_16x16x32_bf16 a[108:111], a[236:239], v[60:63], a[108:111]
    v_mfma_f32_16x16x32_bf16 a[112:115], a[240:243], v[60:63], a[112:115]
    v_mfma_f32_16x16x32_bf16 a[116:119], a[244:247], v[60:63], a[116:119]
    v_mfma_f32_16x16x32_bf16 a[120:123], a[248:251], v[60:63], a[120:123]
    v_mfma_f32_16x16x32_bf16 a[124:127], a[252:255], v[60:63], a[124:127]
    v_mfma_f32_16x16x32_bf16 v[208:211], v[8:11], v[60:63], v[208:211]
    v_accvgpr_read_b32 v228, a64
    v_accvgpr_read_b32 v229, a65
    v_cvt_pk_bf16_f32 v144, v228, v229
    v_accvgpr_read_b32 v230, a66
    v_accvgpr_read_b32 v231, a67
    v_cvt_pk_bf16_f32 v145, v230, v231
    v_accvgpr_read_b32 v228, a68
    v_accvgpr_read_b32 v229, a69
    v_cvt_pk_bf16_f32 v146, v228, v229
    v_accvgpr_read_b32 v230, a70
    v_accvgpr_read_b32 v231, a71
    v_cvt_pk_bf16_f32 v147, v230, v231
    buffer_store_dwordx4 v[144:147], v46, s[40:43], s64 offen offset:0 sc1
    v_accvgpr_read_b32 v228, a72
    v_accvgpr_read_b32 v229, a73
    v_cvt_pk_bf16_f32 v148, v228, v229
    v_accvgpr_read_b32 v230, a74
    v_accvgpr_read_b32 v231, a75
    v_cvt_pk_bf16_f32 v149, v230, v231
    v_accvgpr_read_b32 v228, a76
    v_accvgpr_read_b32 v229, a77
    v_cvt_pk_bf16_f32 v150, v228, v229
    v_accvgpr_read_b32 v230, a78
    v_accvgpr_read_b32 v231, a79
    v_cvt_pk_bf16_f32 v151, v230, v231
    buffer_store_dwordx4 v[148:151], v46, s[40:43], s64 offen offset:1024 sc1
    v_accvgpr_read_b32 v228, a80
    v_accvgpr_read_b32 v229, a81
    v_cvt_pk_bf16_f32 v152, v228, v229
    v_accvgpr_read_b32 v230, a82
    v_accvgpr_read_b32 v231, a83
    v_cvt_pk_bf16_f32 v153, v230, v231
    v_accvgpr_read_b32 v228, a84
    v_accvgpr_read_b32 v229, a85
    v_cvt_pk_bf16_f32 v154, v228, v229
    v_accvgpr_read_b32 v230, a86
    v_accvgpr_read_b32 v231, a87
    v_cvt_pk_bf16_f32 v155, v230, v231
    buffer_store_dwordx4 v[152:155], v46, s[40:43], s65 offen offset:0 sc1
    v_accvgpr_read_b32 v228, a88
    v_accvgpr_read_b32 v229, a89
    v_cvt_pk_bf16_f32 v156, v228, v229
    v_accvgpr_read_b32 v230, a90
    v_accvgpr_read_b32 v231, a91
    v_cvt_pk_bf16_f32 v157, v230, v231
    v_accvgpr_read_b32 v228, a92
    v_accvgpr_read_b32 v229, a93
    v_cvt_pk_bf16_f32 v158, v228, v229
    v_accvgpr_read_b32 v230, a94
    v_accvgpr_read_b32 v231, a95
    v_cvt_pk_bf16_f32 v159, v230, v231
    buffer_store_dwordx4 v[156:159], v46, s[40:43], s65 offen offset:1024 sc1
    v_mov_b32 v236, v72
    v_mov_b32 v237, v204
    buffer_store_dwordx2 v[236:237], v47, s[40:43], s68 offen offset:2048 sc1
    s_mov_b32 s49, 0
    s_waitcnt vmcnt(5)
CHK_LOOP:
    v_readfirstlane_b32 s4, v14
    s_add_u32 s49, s49, 1
    s_cmp_ge_u32 s4, 8
    s_cbranch_scc1 CHK_DONE
    s_cmp_ge_u32 s49, 65536
    s_cbranch_scc1 CHK_DONE
    v_mov_b32 v14, 0
    buffer_load_dword v14, v14, s[84:87], s7 offen offset:128 sc1
    s_waitcnt vmcnt(0)
    s_branch CHK_LOOP
CHK_DONE:
    s_lshl_b32 s3, s57, 2
    s_add_u32 s3, s3, s69
    v_lshlrev_b32 v2, 7, v0
    v_mov_b32 v3, 1
    s_mov_b64 exec, 3
    buffer_store_dword v3, v2, s[40:43], s3 offen offset:0 sc1
    s_mov_b64 exec, -1
    v_accvgpr_read_b32 v228, a96
    v_accvgpr_read_b32 v229, a97
    v_cvt_pk_bf16_f32 v160, v228, v229
    v_accvgpr_read_b32 v230, a98
    v_accvgpr_read_b32 v231, a99
    v_cvt_pk_bf16_f32 v161, v230, v231
    v_accvgpr_read_b32 v228, a100
    v_accvgpr_read_b32 v229, a101
    v_cvt_pk_bf16_f32 v162, v228, v229
    v_accvgpr_read_b32 v230, a102
    v_accvgpr_read_b32 v231, a103
    v_cvt_pk_bf16_f32 v163, v230, v231
    buffer_store_dwordx4 v[160:163], v46, s[40:43], s64 offen offset:2048 sc1
    v_accvgpr_read_b32 v228, a104
    v_accvgpr_read_b32 v229, a105
    v_cvt_pk_bf16_f32 v164, v228, v229
    v_accvgpr_read_b32 v230, a106
    v_accvgpr_read_b32 v231, a107
    v_cvt_pk_bf16_f32 v165, v230, v231
    v_accvgpr_read_b32 v228, a108
    v_accvgpr_read_b32 v229, a109
    v_cvt_pk_bf16_f32 v166, v228, v229
    v_accvgpr_read_b32 v230, a110
    v_accvgpr_read_b32 v231, a111
    v_cvt_pk_bf16_f32 v167, v230, v231
    buffer_store_dwordx4 v[164:167], v46, s[40:43], s64 offen offset:3072 sc1
    v_accvgpr_read_b32 v228, a112
    v_accvgpr_read_b32 v229, a113
    v_cvt_pk_bf16_f32 v168, v228, v229
    v_accvgpr_read_b32 v230, a114
    v_accvgpr_read_b32 v231, a115
    v_cvt_pk_bf16_f32 v169, v230, v231
    v_accvgpr_read_b32 v228, a116
    v_accvgpr_read_b32 v229, a117
    v_cvt_pk_bf16_f32 v170, v228, v229
    v_accvgpr_read_b32 v230, a118
    v_accvgpr_read_b32 v231, a119
    v_cvt_pk_bf16_f32 v171, v230, v231
    buffer_store_dwordx4 v[168:171], v46, s[40:43], s65 offen offset:2048 sc1
    v_accvgpr_read_b32 v228, a120
    v_accvgpr_read_b32 v229, a121
    v_cvt_pk_bf16_f32 v172, v228, v229
    v_accvgpr_read_b32 v230, a122
    v_accvgpr_read_b32 v231, a123
    v_cvt_pk_bf16_f32 v173, v230, v231
    v_accvgpr_read_b32 v228, a124
    v_accvgpr_read_b32 v229, a125
    v_cvt_pk_bf16_f32 v174, v228, v229
    v_accvgpr_read_b32 v230, a126
    v_accvgpr_read_b32 v231, a127
    v_cvt_pk_bf16_f32 v175, v230, v231
    buffer_store_dwordx4 v[172:175], v46, s[40:43], s65 offen offset:3072 sc1
    v_mov_b32 v238, v76
    v_mov_b32 v239, v208
    buffer_store_dwordx2 v[238:239], v47, s[40:43], s68 offen offset:2176 sc1
    v_and_b32 v20, 7, v0
    v_lshlrev_b32 v20, 2, v20
    s_lshr_b32 s4, s44, 1
    s_lshl_b32 s4, s4, 5
    s_add_u32 s50, s50, s4
    s_lshl_b32 s3, s56, 3
    s_add_u32 s3, s3, s93
    s_lshl_b32 s58, s3, 16
    s_lshl_b32 s4, s95, 12
    s_add_u32 s58, s58, s4
    s_lshl_b32 s4, s94, 11
    s_add_u32 s58, s58, s4
    s_lshl_b32 s59, s3, 11
    s_add_u32 s59, s59, 0x1000000
    s_lshl_b32 s4, s94, 7
    s_add_u32 s59, s59, s4
    v_and_b32 v21, 15, v0
    v_lshlrev_b32 v21, 8, v21
    v_lshrrev_b32 v23, 4, v0
    v_lshl_add_u32 v21, v23, 3, v21
    s_lshl_b32 s64, s93, 13
    s_lshl_b32 s4, s94, 12
    s_add_u32 s64, s64, s4
    s_lshl_b32 s4, s95, 7
    s_add_u32 s64, s64, s4
    s_mov_b32 s49, 0
    s_waitcnt vmcnt(0)
    s_lshl_b32 s3, s57, 2
    s_add_u32 s3, s3, s69
    v_lshlrev_b32 v2, 7, v0
    v_mov_b32 v3, 1
    s_mov_b64 exec, 3
    buffer_store_dword v3, v2, s[40:43], s3 offen offset:32 sc1
    s_mov_b64 exec, -1
    buffer_load_dword v22, v20, s[40:43], s50 offen sc1
    s_waitcnt vmcnt(0)
POLL:
    v_cmp_ne_u32 vcc, 1, v22
    s_cbranch_vccz POLL_DONE
    s_add_u32 s49, s49, 1
    s_cmp_ge_u32 s49, 65536
    s_cbranch_scc1 POLL_DONE
    buffer_load_dword v22, v20, s[40:43], s50 offen sc1
    s_waitcnt vmcnt(0)
    s_branch POLL
POLL_DONE:
    s_mov_b32 s49, 0
ROUND:
    buffer_load_dwordx2 v[224:225], v47, s[40:43], s59 offen offset:0 sc1
    buffer_load_dwordx2 v[226:227], v47, s[40:43], s59 offen offset:256 sc1
    buffer_load_dwordx2 v[228:229], v47, s[40:43], s59 offen offset:512 sc1
    buffer_load_dwordx2 v[230:231], v47, s[40:43], s59 offen offset:768 sc1
    buffer_load_dwordx2 v[232:233], v47, s[40:43], s59 offen offset:1024 sc1
    buffer_load_dwordx2 v[234:235], v47, s[40:43], s59 offen offset:1280 sc1
    buffer_load_dwordx2 v[236:237], v47, s[40:43], s59 offen offset:1536 sc1
    buffer_load_dwordx2 v[238:239], v47, s[40:43], s59 offen offset:1792 sc1
    s_add_u32 s3, s58, 0
    buffer_load_dwordx4 v[112:115], v46, s[40:43], s3 offen offset:0 sc1
    buffer_load_dwordx4 v[116:119], v46, s[40:43], s3 offen offset:1024 sc1
    s_add_u32 s3, s58, 8192
    buffer_load_dwordx4 v[120:123], v46, s[40:43], s3 offen offset:0 sc1
    buffer_load_dwordx4 v[124:127], v46, s[40:43], s3 offen offset:1024 sc1
    s_add_u32 s3, s58, 16384
    buffer_load_dwordx4 v[128:131], v46, s[40:43], s3 offen offset:0 sc1
    buffer_load_dwordx4 v[132:135], v46, s[40:43], s3 offen offset:1024 sc1
    s_add_u32 s3, s58, 24576
    buffer_load_dwordx4 v[136:139], v46, s[40:43], s3 offen offset:0 sc1
    buffer_load_dwordx4 v[140:143], v46, s[40:43], s3 offen offset:1024 sc1
    s_add_u32 s3, s58, 32768
    buffer_load_dwordx4 v[144:147], v46, s[40:43], s3 offen offset:0 sc1
    buffer_load_dwordx4 v[148:151], v46, s[40:43], s3 offen offset:1024 sc1
    s_add_u32 s3, s58, 40960
    buffer_load_dwordx4 v[152:155], v46, s[40:43], s3 offen offset:0 sc1
    buffer_load_dwordx4 v[156:159], v46, s[40:43], s3 offen offset:1024 sc1
    s_add_u32 s3, s58, 49152
    buffer_load_dwordx4 v[160:163], v46, s[40:43], s3 offen offset:0 sc1
    buffer_load_dwordx4 v[164:167], v46, s[40:43], s3 offen offset:1024 sc1
    s_add_u32 s3, s58, 57344
    buffer_load_dwordx4 v[168:171], v46, s[40:43], s3 offen offset:0 sc1
    buffer_load_dwordx4 v[172:175], v46, s[40:43], s3 offen offset:1024 sc1
    s_add_u32 s49, s49, 1
    v_sub_f32 v20, 0, v192
    s_waitcnt vmcnt(16)
    v_min3_f32 v23, v20, v224, v226
    v_min3_f32 v23, v23, v228, v230
    v_min3_f32 v23, v23, v232, v234
    v_min3_f32 v23, v23, v236, v238
    v_sub_f32 v20, v23, v20
    v_cvt_i32_f32 v20, v20
    v_max_i32 v20, 0xffffff00, v20
    v_ldexp_f32 v20, 1.0, v20
    v_sub_f32 v80, v23, v224
    v_cvt_i32_f32 v80, v80
    v_max_i32 v80, 0xffffff00, v80
    v_ldexp_f32 v80, 1.0, v80
    v_and_b32 v80, 0x7f800000, v80
    v_lshrrev_b32 v81, 16, v80
    v_sub_f32 v82, v23, v226
    v_cvt_i32_f32 v82, v82
    v_max_i32 v82, 0xffffff00, v82
    v_ldexp_f32 v82, 1.0, v82
    v_and_b32 v82, 0x7f800000, v82
    v_lshrrev_b32 v83, 16, v82
    v_sub_f32 v84, v23, v228
    v_cvt_i32_f32 v84, v84
    v_max_i32 v84, 0xffffff00, v84
    v_ldexp_f32 v84, 1.0, v84
    v_and_b32 v84, 0x7f800000, v84
    v_lshrrev_b32 v85, 16, v84
    v_sub_f32 v86, v23, v230
    v_cvt_i32_f32 v86, v86
    v_max_i32 v86, 0xffffff00, v86
    v_ldexp_f32 v86, 1.0, v86
    v_and_b32 v86, 0x7f800000, v86
    v_lshrrev_b32 v87, 16, v86
    v_sub_f32 v88, v23, v232
    v_cvt_i32_f32 v88, v88
    v_max_i32 v88, 0xffffff00, v88
    v_ldexp_f32 v88, 1.0, v88
    v_and_b32 v88, 0x7f800000, v88
    v_lshrrev_b32 v89, 16, v88
    v_sub_f32 v90, v23, v234
    v_cvt_i32_f32 v90, v90
    v_max_i32 v90, 0xffffff00, v90
    v_ldexp_f32 v90, 1.0, v90
    v_and_b32 v90, 0x7f800000, v90
    v_lshrrev_b32 v91, 16, v90
    v_sub_f32 v92, v23, v236
    v_cvt_i32_f32 v92, v92
    v_max_i32 v92, 0xffffff00, v92
    v_ldexp_f32 v92, 1.0, v92
    v_and_b32 v92, 0x7f800000, v92
    v_lshrrev_b32 v93, 16, v92
    v_sub_f32 v94, v23, v238
    v_cvt_i32_f32 v94, v94
    v_max_i32 v94, 0xffffff00, v94
    v_ldexp_f32 v94, 1.0, v94
    v_and_b32 v94, 0x7f800000, v94
    v_lshrrev_b32 v95, 16, v94
    v_mul_f32 v22, v20, v193
    v_fmac_f32 v22, v80, v225
    v_fmac_f32 v22, v82, v227
    v_fmac_f32 v22, v84, v229
    v_fmac_f32 v22, v86, v231
    v_fmac_f32 v22, v88, v233
    v_fmac_f32 v22, v90, v235
    v_fmac_f32 v22, v92, v237
    v_fmac_f32 v22, v94, v239
    v_rcp_f32 v22, v22
    v_mul_f32 v64, v176, v20
    v_mul_f32 v65, v177, v20
    v_mul_f32 v66, v178, v20
    v_mul_f32 v67, v179, v20
    v_mul_f32 v68, v180, v20
    v_mul_f32 v69, v181, v20
    v_mul_f32 v70, v182, v20
    v_mul_f32 v71, v183, v20
    v_mul_f32 v72, v184, v20
    v_mul_f32 v73, v185, v20
    v_mul_f32 v74, v186, v20
    v_mul_f32 v75, v187, v20
    v_mul_f32 v76, v188, v20
    v_mul_f32 v77, v189, v20
    v_mul_f32 v78, v190, v20
    v_mul_f32 v79, v191, v20
    v_mov_b32 v16, 0
    s_waitcnt vmcnt(14)
    v_dot2_f32_bf16 v64, v112, v81, v64
    v_dot2_f32_bf16 v65, v112, v80, v65
    v_dot2_f32_bf16 v66, v113, v81, v66
    v_dot2_f32_bf16 v67, v113, v80, v67
    v_dot2_f32_bf16 v68, v114, v81, v68
    v_dot2_f32_bf16 v69, v114, v80, v69
    v_dot2_f32_bf16 v70, v115, v81, v70
    v_dot2_f32_bf16 v71, v115, v80, v71
    v_dot2_f32_bf16 v72, v116, v81, v72
    v_dot2_f32_bf16 v73, v116, v80, v73
    v_dot2_f32_bf16 v74, v117, v81, v74
    v_dot2_f32_bf16 v75, v117, v80, v75
    v_dot2_f32_bf16 v76, v118, v81, v76
    v_dot2_f32_bf16 v77, v118, v80, v77
    v_dot2_f32_bf16 v78, v119, v81, v78
    v_dot2_f32_bf16 v79, v119, v80, v79
    s_waitcnt vmcnt(12)
    v_dot2_f32_bf16 v64, v120, v83, v64
    v_dot2_f32_bf16 v65, v120, v82, v65
    v_dot2_f32_bf16 v66, v121, v83, v66
    v_dot2_f32_bf16 v67, v121, v82, v67
    v_dot2_f32_bf16 v68, v122, v83, v68
    v_dot2_f32_bf16 v69, v122, v82, v69
    v_dot2_f32_bf16 v70, v123, v83, v70
    v_dot2_f32_bf16 v71, v123, v82, v71
    v_dot2_f32_bf16 v72, v124, v83, v72
    v_dot2_f32_bf16 v73, v124, v82, v73
    v_dot2_f32_bf16 v74, v125, v83, v74
    v_dot2_f32_bf16 v75, v125, v82, v75
    v_dot2_f32_bf16 v76, v126, v83, v76
    v_dot2_f32_bf16 v77, v126, v82, v77
    v_dot2_f32_bf16 v78, v127, v83, v78
    v_dot2_f32_bf16 v79, v127, v82, v79
    s_waitcnt vmcnt(10)
    v_dot2_f32_bf16 v64, v128, v85, v64
    v_dot2_f32_bf16 v65, v128, v84, v65
    v_dot2_f32_bf16 v66, v129, v85, v66
    v_dot2_f32_bf16 v67, v129, v84, v67
    v_dot2_f32_bf16 v68, v130, v85, v68
    v_dot2_f32_bf16 v69, v130, v84, v69
    v_dot2_f32_bf16 v70, v131, v85, v70
    v_dot2_f32_bf16 v71, v131, v84, v71
    v_dot2_f32_bf16 v72, v132, v85, v72
    v_dot2_f32_bf16 v73, v132, v84, v73
    v_dot2_f32_bf16 v74, v133, v85, v74
    v_dot2_f32_bf16 v75, v133, v84, v75
    v_dot2_f32_bf16 v76, v134, v85, v76
    v_dot2_f32_bf16 v77, v134, v84, v77
    v_dot2_f32_bf16 v78, v135, v85, v78
    v_dot2_f32_bf16 v79, v135, v84, v79
    s_waitcnt vmcnt(8)
    v_dot2_f32_bf16 v64, v136, v87, v64
    v_dot2_f32_bf16 v65, v136, v86, v65
    v_dot2_f32_bf16 v66, v137, v87, v66
    v_dot2_f32_bf16 v67, v137, v86, v67
    v_dot2_f32_bf16 v68, v138, v87, v68
    v_dot2_f32_bf16 v69, v138, v86, v69
    v_dot2_f32_bf16 v70, v139, v87, v70
    v_dot2_f32_bf16 v71, v139, v86, v71
    v_dot2_f32_bf16 v72, v140, v87, v72
    v_dot2_f32_bf16 v73, v140, v86, v73
    v_dot2_f32_bf16 v74, v141, v87, v74
    v_dot2_f32_bf16 v75, v141, v86, v75
    v_dot2_f32_bf16 v76, v142, v87, v76
    v_dot2_f32_bf16 v77, v142, v86, v77
    v_dot2_f32_bf16 v78, v143, v87, v78
    v_dot2_f32_bf16 v79, v143, v86, v79
    s_waitcnt vmcnt(6)
    v_dot2_f32_bf16 v64, v144, v89, v64
    v_dot2_f32_bf16 v65, v144, v88, v65
    v_dot2_f32_bf16 v66, v145, v89, v66
    v_dot2_f32_bf16 v67, v145, v88, v67
    v_dot2_f32_bf16 v68, v146, v89, v68
    v_dot2_f32_bf16 v69, v146, v88, v69
    v_dot2_f32_bf16 v70, v147, v89, v70
    v_dot2_f32_bf16 v71, v147, v88, v71
    v_dot2_f32_bf16 v72, v148, v89, v72
    v_dot2_f32_bf16 v73, v148, v88, v73
    v_dot2_f32_bf16 v74, v149, v89, v74
    v_dot2_f32_bf16 v75, v149, v88, v75
    v_dot2_f32_bf16 v76, v150, v89, v76
    v_dot2_f32_bf16 v77, v150, v88, v77
    v_dot2_f32_bf16 v78, v151, v89, v78
    v_dot2_f32_bf16 v79, v151, v88, v79
    s_waitcnt vmcnt(4)
    v_dot2_f32_bf16 v64, v152, v91, v64
    v_dot2_f32_bf16 v65, v152, v90, v65
    v_dot2_f32_bf16 v66, v153, v91, v66
    v_dot2_f32_bf16 v67, v153, v90, v67
    v_dot2_f32_bf16 v68, v154, v91, v68
    v_dot2_f32_bf16 v69, v154, v90, v69
    v_dot2_f32_bf16 v70, v155, v91, v70
    v_dot2_f32_bf16 v71, v155, v90, v71
    v_dot2_f32_bf16 v72, v156, v91, v72
    v_dot2_f32_bf16 v73, v156, v90, v73
    v_dot2_f32_bf16 v74, v157, v91, v74
    v_dot2_f32_bf16 v75, v157, v90, v75
    v_dot2_f32_bf16 v76, v158, v91, v76
    v_dot2_f32_bf16 v77, v158, v90, v77
    v_dot2_f32_bf16 v78, v159, v91, v78
    v_dot2_f32_bf16 v79, v159, v90, v79
    s_waitcnt vmcnt(2)
    v_dot2_f32_bf16 v64, v160, v93, v64
    v_dot2_f32_bf16 v65, v160, v92, v65
    v_dot2_f32_bf16 v66, v161, v93, v66
    v_dot2_f32_bf16 v67, v161, v92, v67
    v_dot2_f32_bf16 v68, v162, v93, v68
    v_dot2_f32_bf16 v69, v162, v92, v69
    v_dot2_f32_bf16 v70, v163, v93, v70
    v_dot2_f32_bf16 v71, v163, v92, v71
    v_dot2_f32_bf16 v72, v164, v93, v72
    v_dot2_f32_bf16 v73, v164, v92, v73
    v_dot2_f32_bf16 v74, v165, v93, v74
    v_dot2_f32_bf16 v75, v165, v92, v75
    v_dot2_f32_bf16 v76, v166, v93, v76
    v_dot2_f32_bf16 v77, v166, v92, v77
    v_dot2_f32_bf16 v78, v167, v93, v78
    v_dot2_f32_bf16 v79, v167, v92, v79
    s_waitcnt vmcnt(0)
    v_dot2_f32_bf16 v64, v168, v95, v64
    v_dot2_f32_bf16 v65, v168, v94, v65
    v_dot2_f32_bf16 v66, v169, v95, v66
    v_dot2_f32_bf16 v67, v169, v94, v67
    v_dot2_f32_bf16 v68, v170, v95, v68
    v_dot2_f32_bf16 v69, v170, v94, v69
    v_dot2_f32_bf16 v70, v171, v95, v70
    v_dot2_f32_bf16 v71, v171, v94, v71
    v_dot2_f32_bf16 v72, v172, v95, v72
    v_dot2_f32_bf16 v73, v172, v94, v73
    v_dot2_f32_bf16 v74, v173, v95, v74
    v_dot2_f32_bf16 v75, v173, v94, v75
    v_dot2_f32_bf16 v76, v174, v95, v76
    v_dot2_f32_bf16 v77, v174, v94, v77
    v_dot2_f32_bf16 v78, v175, v95, v78
    v_dot2_f32_bf16 v79, v175, v94, v79
    s_nop 3
    v_mul_f32 v64, v64, v22
    v_mul_f32 v65, v65, v22
    v_mul_f32 v66, v66, v22
    v_mul_f32 v67, v67, v22
    v_mul_f32 v68, v68, v22
    v_mul_f32 v69, v69, v22
    v_mul_f32 v70, v70, v22
    v_mul_f32 v71, v71, v22
    v_mul_f32 v72, v72, v22
    v_mul_f32 v73, v73, v22
    v_mul_f32 v74, v74, v22
    v_mul_f32 v75, v75, v22
    v_mul_f32 v76, v76, v22
    v_mul_f32 v77, v77, v22
    v_mul_f32 v78, v78, v22
    v_mul_f32 v79, v79, v22
    v_cvt_pk_bf16_f32 v96, v64, v65
    v_cvt_pk_bf16_f32 v97, v66, v67
    buffer_store_dwordx2 v[96:97], v21, s[88:91], s64 offen offset:0
    v_cvt_pk_bf16_f32 v98, v68, v69
    v_cvt_pk_bf16_f32 v99, v70, v71
    buffer_store_dwordx2 v[98:99], v21, s[88:91], s64 offen offset:32
    v_cvt_pk_bf16_f32 v100, v72, v73
    v_cvt_pk_bf16_f32 v101, v74, v75
    buffer_store_dwordx2 v[100:101], v21, s[88:91], s64 offen offset:64
    v_cvt_pk_bf16_f32 v102, v76, v77
    v_cvt_pk_bf16_f32 v103, v78, v79
    buffer_store_dwordx2 v[102:103], v21, s[88:91], s64 offen offset:96
MAIN_END:
    s_endpgm
STUB_Ap1:
    s_call_b64 s[52:53], RARE_0
    s_call_b64 s[52:53], RARE_1
    s_branch BACK_Ap1
STUB_Bl0:
    s_call_b64 s[52:53], RARE_2
    s_call_b64 s[52:53], RARE_3
    s_branch BACK_Bl0
STUB_Al0:
    s_call_b64 s[52:53], RARE_0
    s_call_b64 s[52:53], RARE_1
    s_branch BACK_Al0
STUB_Bl1:
    s_call_b64 s[52:53], RARE_2
    s_call_b64 s[52:53], RARE_3
    s_branch BACK_Bl1
STUB_Al1:
    s_call_b64 s[52:53], RARE_0
    s_call_b64 s[52:53], RARE_1
    s_branch BACK_Al1
STUB_Bl2:
    s_call_b64 s[52:53], RARE_2
    s_call_b64 s[52:53], RARE_3
    s_branch BACK_Bl2
STUB_Al2:
    s_call_b64 s[52:53], RARE_0
    s_call_b64 s[52:53], RARE_1
    s_branch BACK_Al2
STUB_Bl3:
    s_call_b64 s[52:53], RARE_2
    s_call_b64 s[52:53], RARE_3
    s_branch BACK_Bl3
STUB_Al3:
    s_call_b64 s[52:53], RARE_0
    s_call_b64 s[52:53], RARE_1
    s_branch BACK_Al3
STUB_Bt:
    s_call_b64 s[52:53], RARE_2
    s_call_b64 s[52:53], RARE_3
    s_branch BACK_Bt
STUB_E0_0:
    s_call_b64 s[52:53], RARE_0
    s_branch BACK_E0_0
STUB_E1_0:
    s_call_b64 s[52:53], RARE_1
    s_branch BACK_E1_0
STUB_E0_1:
    s_call_b64 s[52:53], RARE_0
    s_branch BACK_E0_1
STUB_E1_1:
    s_call_b64 s[52:53], RARE_1
    s_branch BACK_E1_1
STUB_E0_2:
    s_call_b64 s[52:53], RARE_0
    s_branch BACK_E0_2
STUB_E1_2:
    s_call_b64 s[52:53], RARE_1
    s_branch BACK_E1_2
STUB_E0_3:
    s_call_b64 s[52:53], RARE_0
    s_branch BACK_E0_3
STUB_E1_3:
    s_call_b64 s[52:53], RARE_1
    s_branch BACK_E1_3
STUB_E2_4:
    s_call_b64 s[52:53], RARE_2
    s_branch BACK_E2_4
STUB_E3_4:
    s_call_b64 s[52:53], RARE_3
    s_branch BACK_E3_4
STUB_E2_5:
    s_call_b64 s[52:53], RARE_2
    s_branch BACK_E2_5
STUB_E3_5:
    s_call_b64 s[52:53], RARE_3
    s_branch BACK_E3_5
STUB_E2_6:
    s_call_b64 s[52:53], RARE_2
    s_branch BACK_E2_6
STUB_E3_6:
    s_call_b64 s[52:53], RARE_3
    s_branch BACK_E3_6
STUB_E2_7:
    s_call_b64 s[52:53], RARE_2
    s_branch BACK_E2_7
STUB_E3_7:
    s_call_b64 s[52:53], RARE_3
    s_branch BACK_E3_7
RARE_0:
    s_nop 15
    v_mov_b32 v240, v32
    v_mov_b32 v241, v33
    v_mov_b32 v242, v34
    v_mov_b32 v243, v35
    v_mov_b32 v244, v36
    v_mov_b32 v245, v37
    v_mov_b32 v246, v38
    v_mov_b32 v247, v39
    v_max3_f32 v248, v80, v81, v82
    v_max3_f32 v248, v248, v83, v84
    v_max3_f32 v248, v248, v85, v86
    v_max_f32 v248, v248, v87
    v_mov_b32 v249, v248
    s_nop 1
    v_permlane32_swap_b32 v248, v249
    v_max_f32 v248, v248, v249
    v_mov_b32 v249, v248
    s_nop 1
    v_permlane16_swap_b32 v248, v249
    v_max_f32 v248, v248, v249
    v_ceil_f32 v248, v248
    v_add_f32 v248, 0x41000000, v248
    v_max_f32 v248, 0, v248
    v_sub_f32 v249, 0, v248
    v_exp_f32 v249, v249
    v_sub_f32 v80, v80, v248
    v_sub_f32 v81, v81, v248
    v_sub_f32 v82, v82, v248
    v_sub_f32 v83, v83, v248
    v_sub_f32 v84, v84, v248
    v_sub_f32 v85, v85, v248
    v_sub_f32 v86, v86, v248
    v_sub_f32 v87, v87, v248
    v_sub_f32 v64, v64, v248
    v_sub_f32 v65, v65, v248
    v_sub_f32 v66, v66, v248
    v_sub_f32 v67, v67, v248
    v_accvgpr_read_b32 v250, a0
    v_mul_f32 v250, v250, v249
    v_accvgpr_write_b32 a0, v250
    v_accvgpr_read_b32 v251, a1
    v_mul_f32 v251, v251, v249
    v_accvgpr_write_b32 a1, v251
    v_accvgpr_read_b32 v252, a2
    v_mul_f32 v252, v252, v249
    v_accvgpr_write_b32 a2, v252
    v_accvgpr_read_b32 v253, a3
    v_mul_f32 v253, v253, v249
    v_accvgpr_write_b32 a3, v253
    v_accvgpr_read_b32 v250, a4
    v_mul_f32 v250, v250, v249
    v_accvgpr_write_b32 a4, v250
    v_accvgpr_read_b32 v251, a5
    v_mul_f32 v251, v251, v249
    v_accvgpr_write_b32 a5, v251
    v_accvgpr_read_b32 v252, a6
    v_mul_f32 v252, v252, v249
    v_accvgpr_write_b32 a6, v252
    v_accvgpr_read_b32 v253, a7
    v_mul_f32 v253, v253, v249
    v_accvgpr_write_b32 a7, v253
    v_accvgpr_read_b32 v250, a8
    v_mul_f32 v250, v250, v249
    v_accvgpr_write_b32 a8, v250
    v_accvgpr_read_b32 v251, a9
    v_mul_f32 v251, v251, v249
    v_accvgpr_write_b32 a9, v251
    v_accvgpr_read_b32 v252, a10
    v_mul_f32 v252, v252, v249
    v_accvgpr_write_b32 a10, v252
    v_accvgpr_read_b32 v253, a11
    v_mul_f32 v253, v253, v249
    v_accvgpr_write_b32 a11, v253
    v_accvgpr_read_b32 v250, a12
    v_mul_f32 v250, v250, v249
    v_accvgpr_write_b32 a12, v250
    v_accvgpr_read_b32 v251, a13
    v_mul_f32 v251, v251, v249
    v_accvgpr_write_b32 a13, v251
    v_accvgpr_read_b32 v252, a14
    v_mul_f32 v252, v252, v249
    v_accvgpr_write_b32 a14, v252
    v_accvgpr_read_b32 v253, a15
    v_mul_f32 v253, v253, v249
    v_accvgpr_write_b32 a15, v253
    v_accvgpr_read_b32 v250, a16
    v_mul_f32 v250, v250, v249
    v_accvgpr_write_b32 a16, v250
    v_accvgpr_read_b32 v251, a17
    v_mul_f32 v251, v251, v249
    v_accvgpr_write_b32 a17, v251
    v_accvgpr_read_b32 v252, a18
    v_mul_f32 v252, v252, v249
    v_accvgpr_write_b32 a18, v252
    v_accvgpr_read_b32 v253, a19
    v_mul_f32 v253, v253, v249
    v_accvgpr_write_b32 a19, v253
    v_accvgpr_read_b32 v250, a20
    v_mul_f32 v250, v250, v249
    v_accvgpr_write_b32 a20, v250
    v_accvgpr_read_b32 v251, a21
    v_mul_f32 v251, v251, v249
    v_accvgpr_write_b32 a21, v251
    v_accvgpr_read_b32 v252, a22
    v_mul_f32 v252, v252, v249
    v_accvgpr_write_b32 a22, v252
    v_accvgpr_read_b32 v253, a23
    v_mul_f32 v253, v253, v249
    v_accvgpr_write_b32 a23, v253
    v_accvgpr_read_b32 v250, a24
    v_mul_f32 v250, v250, v249
    v_accvgpr_write_b32 a24, v250
    v_accvgpr_read_b32 v251, a25
    v_mul_f32 v251, v251, v249
    v_accvgpr_write_b32 a25, v251
    v_accvgpr_read_b32 v252, a26
    v_mul_f32 v252, v252, v249
    v_accvgpr_write_b32 a26, v252
    v_accvgpr_read_b32 v253, a27
    v_mul_f32 v253, v253, v249
    v_accvgpr_write_b32 a27, v253
    v_accvgpr_read_b32 v250, a28
    v_mul_f32 v250, v250, v249
    v_accvgpr_write_b32 a28, v250
    v_accvgpr_read_b32 v251, a29
    v_mul_f32 v251, v251, v249
    v_accvgpr_write_b32 a29, v251
    v_accvgpr_read_b32 v252, a30
    v_mul_f32 v252, v252, v249
    v_accvgpr_write_b32 a30, v252
    v_accvgpr_read_b32 v253, a31
    v_mul_f32 v253, v253, v249
    v_accvgpr_write_b32 a31, v253
    v_mul_f32 v196, v196, v249
    v_mul_f32 v197, v197, v249
    v_mul_f32 v198, v198, v249
    v_mul_f32 v199, v199, v249
    v_exp_f32 v32, v80
    v_exp_f32 v33, v81
    v_exp_f32 v34, v82
    v_cvt_pk_bf16_f32 v48, v32, v33
    v_exp_f32 v35, v83
    v_exp_f32 v36, v84
    v_cvt_pk_bf16_f32 v49, v34, v35
    v_exp_f32 v37, v85
    v_exp_f32 v38, v86
    v_cvt_pk_bf16_f32 v50, v36, v37
    v_exp_f32 v39, v87
    s_nop 0
    v_cvt_pk_bf16_f32 v51, v38, v39
    v_mov_b32 v32, v240
    v_mov_b32 v33, v241
    v_mov_b32 v34, v242
    v_mov_b32 v35, v243
    v_mov_b32 v36, v244
    v_mov_b32 v37, v245
    v_mov_b32 v38, v246
    v_mov_b32 v39, v247
    s_nop 3
    s_setpc_b64 s[52:53]
RARE_1:
    s_nop 15
    v_mov_b32 v240, v32
    v_mov_b32 v241, v33
    v_mov_b32 v242, v34
    v_mov_b32 v243, v35
    v_mov_b32 v244, v36
    v_mov_b32 v245, v37
    v_mov_b32 v246, v38
    v_mov_b32 v247, v39
    v_max3_f32 v248, v88, v89, v90
    v_max3_f32 v248, v248, v91, v92
    v_max3_f32 v248, v248, v93, v94
    v_max_f32 v248, v248, v95
    v_mov_b32 v249, v248
    s_nop 1
    v_permlane32_swap_b32 v248, v249
    v_max_f32 v248, v248, v249
    v_mov_b32 v249, v248
    s_nop 1
    v_permlane16_swap_b32 v248, v249
    v_max_f32 v248, v248, v249
    v_ceil_f32 v248, v248
    v_add_f32 v248, 0x41000000, v248
    v_max_f32 v248, 0, v248
    v_sub_f32 v249, 0, v248
    v_exp_f32 v249, v249
    v_sub_f32 v88, v88, v248
    v_sub_f32 v89, v89, v248
    v_sub_f32 v90, v90, v248
    v_sub_f32 v91, v91, v248
    v_sub_f32 v92, v92, v248
    v_sub_f32 v93, v93, v248
    v_sub_f32 v94, v94, v248
    v_sub_f32 v95, v95, v248
    v_sub_f32 v68, v68, v248
    v_sub_f32 v69, v69, v248
    v_sub_f32 v70, v70, v248
    v_sub_f32 v71, v71, v248
    v_accvgpr_read_b32 v250, a32
    v_mul_f32 v250, v250, v249
    v_accvgpr_write_b32 a32, v250
    v_accvgpr_read_b32 v251, a33
    v_mul_f32 v251, v251, v249
    v_accvgpr_write_b32 a33, v251
    v_accvgpr_read_b32 v252, a34
    v_mul_f32 v252, v252, v249
    v_accvgpr_write_b32 a34, v252
    v_accvgpr_read_b32 v253, a35
    v_mul_f32 v253, v253, v249
    v_accvgpr_write_b32 a35, v253
    v_accvgpr_read_b32 v250, a36
    v_mul_f32 v250, v250, v249
    v_accvgpr_write_b32 a36, v250
    v_accvgpr_read_b32 v251, a37
    v_mul_f32 v251, v251, v249
    v_accvgpr_write_b32 a37, v251
    v_accvgpr_read_b32 v252, a38
    v_mul_f32 v252, v252, v249
    v_accvgpr_write_b32 a38, v252
    v_accvgpr_read_b32 v253, a39
    v_mul_f32 v253, v253, v249
    v_accvgpr_write_b32 a39, v253
    v_accvgpr_read_b32 v250, a40
    v_mul_f32 v250, v250, v249
    v_accvgpr_write_b32 a40, v250
    v_accvgpr_read_b32 v251, a41
    v_mul_f32 v251, v251, v249
    v_accvgpr_write_b32 a41, v251
    v_accvgpr_read_b32 v252, a42
    v_mul_f32 v252, v252, v249
    v_accvgpr_write_b32 a42, v252
    v_accvgpr_read_b32 v253, a43
    v_mul_f32 v253, v253, v249
    v_accvgpr_write_b32 a43, v253
    v_accvgpr_read_b32 v250, a44
    v_mul_f32 v250, v250, v249
    v_accvgpr_write_b32 a44, v250
    v_accvgpr_read_b32 v251, a45
    v_mul_f32 v251, v251, v249
    v_accvgpr_write_b32 a45, v251
    v_accvgpr_read_b32 v252, a46
    v_mul_f32 v252, v252, v249
    v_accvgpr_write_b32 a46, v252
    v_accvgpr_read_b32 v253, a47
    v_mul_f32 v253, v253, v249
    v_accvgpr_write_b32 a47, v253
    v_accvgpr_read_b32 v250, a48
    v_mul_f32 v250, v250, v249
    v_accvgpr_write_b32 a48, v250
    v_accvgpr_read_b32 v251, a49
    v_mul_f32 v251, v251, v249
    v_accvgpr_write_b32 a49, v251
    v_accvgpr_read_b32 v252, a50
    v_mul_f32 v252, v252, v249
    v_accvgpr_write_b32 a50, v252
    v_accvgpr_read_b32 v253, a51
    v_mul_f32 v253, v253, v249
    v_accvgpr_write_b32 a51, v253
    v_accvgpr_read_b32 v250, a52
    v_mul_f32 v250, v250, v249
    v_accvgpr_write_b32 a52, v250
    v_accvgpr_read_b32 v251, a53
    v_mul_f32 v251, v251, v249
    v_accvgpr_write_b32 a53, v251
    v_accvgpr_read_b32 v252, a54
    v_mul_f32 v252, v252, v249
    v_accvgpr_write_b32 a54, v252
    v_accvgpr_read_b32 v253, a55
    v_mul_f32 v253, v253, v249
    v_accvgpr_write_b32 a55, v253
    v_accvgpr_read_b32 v250, a56
    v_mul_f32 v250, v250, v249
    v_accvgpr_write_b32 a56, v250
    v_accvgpr_read_b32 v251, a57
    v_mul_f32 v251, v251, v249
    v_accvgpr_write_b32 a57, v251
    v_accvgpr_read_b32 v252, a58
    v_mul_f32 v252, v252, v249
    v_accvgpr_write_b32 a58, v252
    v_accvgpr_read_b32 v253, a59
    v_mul_f32 v253, v253, v249
    v_accvgpr_write_b32 a59, v253
    v_accvgpr_read_b32 v250, a60
    v_mul_f32 v250, v250, v249
    v_accvgpr_write_b32 a60, v250
    v_accvgpr_read_b32 v251, a61
    v_mul_f32 v251, v251, v249
    v_accvgpr_write_b32 a61, v251
    v_accvgpr_read_b32 v252, a62
    v_mul_f32 v252, v252, v249
    v_accvgpr_write_b32 a62, v252
    v_accvgpr_read_b32 v253, a63
    v_mul_f32 v253, v253, v249
    v_accvgpr_write_b32 a63, v253
    v_mul_f32 v200, v200, v249
    v_mul_f32 v201, v201, v249
    v_mul_f32 v202, v202, v249
    v_mul_f32 v203, v203, v249
    v_exp_f32 v32, v88
    v_exp_f32 v33, v89
    v_exp_f32 v34, v90
    v_cvt_pk_bf16_f32 v52, v32, v33
    v_exp_f32 v35, v91
    v_exp_f32 v36, v92
    v_cvt_pk_bf16_f32 v53, v34, v35
    v_exp_f32 v37, v93
    v_exp_f32 v38, v94
    v_cvt_pk_bf16_f32 v54, v36, v37
    v_exp_f32 v39, v95
    s_nop 0
    v_cvt_pk_bf16_f32 v55, v38, v39
    v_mov_b32 v32, v240
    v_mov_b32 v33, v241
    v_mov_b32 v34, v242
    v_mov_b32 v35, v243
    v_mov_b32 v36, v244
    v_mov_b32 v37, v245
    v_mov_b32 v38, v246
    v_mov_b32 v39, v247
    s_nop 3
    s_setpc_b64 s[52:53]
RARE_2:
    s_nop 15
    v_mov_b32 v240, v32
    v_mov_b32 v241, v33
    v_mov_b32 v242, v34
    v_mov_b32 v243, v35
    v_mov_b32 v244, v36
    v_mov_b32 v245, v37
    v_mov_b32 v246, v38
    v_mov_b32 v247, v39
    v_max3_f32 v248, v96, v97, v98
    v_max3_f32 v248, v248, v99, v100
    v_max3_f32 v248, v248, v101, v102
    v_max_f32 v248, v248, v103
    v_mov_b32 v249, v248
    s_nop 1
    v_permlane32_swap_b32 v248, v249
    v_max_f32 v248, v248, v249
    v_mov_b32 v249, v248
    s_nop 1
    v_permlane16_swap_b32 v248, v249
    v_max_f32 v248, v248, v249
    v_ceil_f32 v248, v248
    v_add_f32 v248, 0x41000000, v248
    v_max_f32 v248, 0, v248
    v_sub_f32 v249, 0, v248
    v_exp_f32 v249, v249
    v_sub_f32 v96, v96, v248
    v_sub_f32 v97, v97, v248
    v_sub_f32 v98, v98, v248
    v_sub_f32 v99, v99, v248
    v_sub_f32 v100, v100, v248
    v_sub_f32 v101, v101, v248
    v_sub_f32 v102, v102, v248
    v_sub_f32 v103, v103, v248
    v_sub_f32 v72, v72, v248
    v_sub_f32 v73, v73, v248
    v_sub_f32 v74, v74, v248
    v_sub_f32 v75, v75, v248
    v_accvgpr_read_b32 v250, a64
    v_mul_f32 v250, v250, v249
    v_accvgpr_write_b32 a64, v250
    v_accvgpr_read_b32 v251, a65
    v_mul_f32 v251, v251, v249
    v_accvgpr_write_b32 a65, v251
    v_accvgpr_read_b32 v252, a66
    v_mul_f32 v252, v252, v249
    v_accvgpr_write_b32 a66, v252
    v_accvgpr_read_b32 v253, a67
    v_mul_f32 v253, v253, v249
    v_accvgpr_write_b32 a67, v253
    v_accvgpr_read_b32 v250, a68
    v_mul_f32 v250, v250, v249
    v_accvgpr_write_b32 a68, v250
    v_accvgpr_read_b32 v251, a69
    v_mul_f32 v251, v251, v249
    v_accvgpr_write_b32 a69, v251
    v_accvgpr_read_b32 v252, a70
    v_mul_f32 v252, v252, v249
    v_accvgpr_write_b32 a70, v252
    v_accvgpr_read_b32 v253, a71
    v_mul_f32 v253, v253, v249
    v_accvgpr_write_b32 a71, v253
    v_accvgpr_read_b32 v250, a72
    v_mul_f32 v250, v250, v249
    v_accvgpr_write_b32 a72, v250
    v_accvgpr_read_b32 v251, a73
    v_mul_f32 v251, v251, v249
    v_accvgpr_write_b32 a73, v251
    v_accvgpr_read_b32 v252, a74
    v_mul_f32 v252, v252, v249
    v_accvgpr_write_b32 a74, v252
    v_accvgpr_read_b32 v253, a75
    v_mul_f32 v253, v253, v249
    v_accvgpr_write_b32 a75, v253
    v_accvgpr_read_b32 v250, a76
    v_mul_f32 v250, v250, v249
    v_accvgpr_write_b32 a76, v250
    v_accvgpr_read_b32 v251, a77
    v_mul_f32 v251, v251, v249
    v_accvgpr_write_b32 a77, v251
    v_accvgpr_read_b32 v252, a78
    v_mul_f32 v252, v252, v249
    v_accvgpr_write_b32 a78, v252
    v_accvgpr_read_b32 v253, a79
    v_mul_f32 v253, v253, v249
    v_accvgpr_write_b32 a79, v253
    v_accvgpr_read_b32 v250, a80
    v_mul_f32 v250, v250, v249
    v_accvgpr_write_b32 a80, v250
    v_accvgpr_read_b32 v251, a81
    v_mul_f32 v251, v251, v249
    v_accvgpr_write_b32 a81, v251
    v_accvgpr_read_b32 v252, a82
    v_mul_f32 v252, v252, v249
    v_accvgpr_write_b32 a82, v252
    v_accvgpr_read_b32 v253, a83
    v_mul_f32 v253, v253, v249
    v_accvgpr_write_b32 a83, v253
    v_accvgpr_read_b32 v250, a84
    v_mul_f32 v250, v250, v249
    v_accvgpr_write_b32 a84, v250
    v_accvgpr_read_b32 v251, a85
    v_mul_f32 v251, v251, v249
    v_accvgpr_write_b32 a85, v251
    v_accvgpr_read_b32 v252, a86
    v_mul_f32 v252, v252, v249
    v_accvgpr_write_b32 a86, v252
    v_accvgpr_read_b32 v253, a87
    v_mul_f32 v253, v253, v249
    v_accvgpr_write_b32 a87, v253
    v_accvgpr_read_b32 v250, a88
    v_mul_f32 v250, v250, v249
    v_accvgpr_write_b32 a88, v250
    v_accvgpr_read_b32 v251, a89
    v_mul_f32 v251, v251, v249
    v_accvgpr_write_b32 a89, v251
    v_accvgpr_read_b32 v252, a90
    v_mul_f32 v252, v252, v249
    v_accvgpr_write_b32 a90, v252
    v_accvgpr_read_b32 v253, a91
    v_mul_f32 v253, v253, v249
    v_accvgpr_write_b32 a91, v253
    v_accvgpr_read_b32 v250, a92
    v_mul_f32 v250, v250, v249
    v_accvgpr_write_b32 a92, v250
    v_accvgpr_read_b32 v251, a93
    v_mul_f32 v251, v251, v249
    v_accvgpr_write_b32 a93, v251
    v_accvgpr_read_b32 v252, a94
    v_mul_f32 v252, v252, v249
    v_accvgpr_write_b32 a94, v252
    v_accvgpr_read_b32 v253, a95
    v_mul_f32 v253, v253, v249
    v_accvgpr_write_b32 a95, v253
    v_mul_f32 v204, v204, v249
    v_mul_f32 v205, v205, v249
    v_mul_f32 v206, v206, v249
    v_mul_f32 v207, v207, v249
    v_exp_f32 v32, v96
    v_exp_f32 v33, v97
    v_exp_f32 v34, v98
    v_cvt_pk_bf16_f32 v56, v32, v33
    v_exp_f32 v35, v99
    v_exp_f32 v36, v100
    v_cvt_pk_bf16_f32 v57, v34, v35
    v_exp_f32 v37, v101
    v_exp_f32 v38, v102
    v_cvt_pk_bf16_f32 v58, v36, v37
    v_exp_f32 v39, v103
    s_nop 0
    v_cvt_pk_bf16_f32 v59, v38, v39
    v_mov_b32 v32, v240
    v_mov_b32 v33, v241
    v_mov_b32 v34, v242
    v_mov_b32 v35, v243
    v_mov_b32 v36, v244
    v_mov_b32 v37, v245
    v_mov_b32 v38, v246
    v_mov_b32 v39, v247
    s_nop 3
    s_setpc_b64 s[52:53]
RARE_3:
    s_nop 15
    v_mov_b32 v240, v32
    v_mov_b32 v241, v33
    v_mov_b32 v242, v34
    v_mov_b32 v243, v35
    v_mov_b32 v244, v36
    v_mov_b32 v245, v37
    v_mov_b32 v246, v38
    v_mov_b32 v247, v39
    v_max3_f32 v248, v104, v105, v106
    v_max3_f32 v248, v248, v107, v108
    v_max3_f32 v248, v248, v109, v110
    v_max_f32 v248, v248, v111
    v_mov_b32 v249, v248
    s_nop 1
    v_permlane32_swap_b32 v248, v249
    v_max_f32 v248, v248, v249
    v_mov_b32 v249, v248
    s_nop 1
    v_permlane16_swap_b32 v248, v249
    v_max_f32 v248, v248, v249
    v_ceil_f32 v248, v248
    v_add_f32 v248, 0x41000000, v248
    v_max_f32 v248, 0, v248
    v_sub_f32 v249, 0, v248
    v_exp_f32 v249, v249
    v_sub_f32 v104, v104, v248
    v_sub_f32 v105, v105, v248
    v_sub_f32 v106, v106, v248
    v_sub_f32 v107, v107, v248
    v_sub_f32 v108, v108, v248
    v_sub_f32 v109, v109, v248
    v_sub_f32 v110, v110, v248
    v_sub_f32 v111, v111, v248
    v_sub_f32 v76, v76, v248
    v_sub_f32 v77, v77, v248
    v_sub_f32 v78, v78, v248
    v_sub_f32 v79, v79, v248
    v_accvgpr_read_b32 v250, a96
    v_mul_f32 v250, v250, v249
    v_accvgpr_write_b32 a96, v250
    v_accvgpr_read_b32 v251, a97
    v_mul_f32 v251, v251, v249
    v_accvgpr_write_b32 a97, v251
    v_accvgpr_read_b32 v252, a98
    v_mul_f32 v252, v252, v249
    v_accvgpr_write_b32 a98, v252
    v_accvgpr_read_b32 v253, a99
    v_mul_f32 v253, v253, v249
    v_accvgpr_write_b32 a99, v253
    v_accvgpr_read_b32 v250, a100
    v_mul_f32 v250, v250, v249
    v_accvgpr_write_b32 a100, v250
    v_accvgpr_read_b32 v251, a101
    v_mul_f32 v251, v251, v249
    v_accvgpr_write_b32 a101, v251
    v_accvgpr_read_b32 v252, a102
    v_mul_f32 v252, v252, v249
    v_accvgpr_write_b32 a102, v252
    v_accvgpr_read_b32 v253, a103
    v_mul_f32 v253, v253, v249
    v_accvgpr_write_b32 a103, v253
    v_accvgpr_read_b32 v250, a104
    v_mul_f32 v250, v250, v249
    v_accvgpr_write_b32 a104, v250
    v_accvgpr_read_b32 v251, a105
    v_mul_f32 v251, v251, v249
    v_accvgpr_write_b32 a105, v251
    v_accvgpr_read_b32 v252, a106
    v_mul_f32 v252, v252, v249
    v_accvgpr_write_b32 a106, v252
    v_accvgpr_read_b32 v253, a107
    v_mul_f32 v253, v253, v249
    v_accvgpr_write_b32 a107, v253
    v_accvgpr_read_b32 v250, a108
    v_mul_f32 v250, v250, v249
    v_accvgpr_write_b32 a108, v250
    v_accvgpr_read_b32 v251, a109
    v_mul_f32 v251, v251, v249
    v_accvgpr_write_b32 a109, v251
    v_accvgpr_read_b32 v252, a110
    v_mul_f32 v252, v252, v249
    v_accvgpr_write_b32 a110, v252
    v_accvgpr_read_b32 v253, a111
    v_mul_f32 v253, v253, v249
    v_accvgpr_write_b32 a111, v253
    v_accvgpr_read_b32 v250, a112
    v_mul_f32 v250, v250, v249
    v_accvgpr_write_b32 a112, v250
    v_accvgpr_read_b32 v251, a113
    v_mul_f32 v251, v251, v249
    v_accvgpr_write_b32 a113, v251
    v_accvgpr_read_b32 v252, a114
    v_mul_f32 v252, v252, v249
    v_accvgpr_write_b32 a114, v252
    v_accvgpr_read_b32 v253, a115
    v_mul_f32 v253, v253, v249
    v_accvgpr_write_b32 a115, v253
    v_accvgpr_read_b32 v250, a116
    v_mul_f32 v250, v250, v249
    v_accvgpr_write_b32 a116, v250
    v_accvgpr_read_b32 v251, a117
    v_mul_f32 v251, v251, v249
    v_accvgpr_write_b32 a117, v251
    v_accvgpr_read_b32 v252, a118
    v_mul_f32 v252, v252, v249
    v_accvgpr_write_b32 a118, v252
    v_accvgpr_read_b32 v253, a119
    v_mul_f32 v253, v253, v249
    v_accvgpr_write_b32 a119, v253
    v_accvgpr_read_b32 v250, a120
    v_mul_f32 v250, v250, v249
    v_accvgpr_write_b32 a120, v250
    v_accvgpr_read_b32 v251, a121
    v_mul_f32 v251, v251, v249
    v_accvgpr_write_b32 a121, v251
    v_accvgpr_read_b32 v252, a122
    v_mul_f32 v252, v252, v249
    v_accvgpr_write_b32 a122, v252
    v_accvgpr_read_b32 v253, a123
    v_mul_f32 v253, v253, v249
    v_accvgpr_write_b32 a123, v253
    v_accvgpr_read_b32 v250, a124
    v_mul_f32 v250, v250, v249
    v_accvgpr_write_b32 a124, v250
    v_accvgpr_read_b32 v251, a125
    v_mul_f32 v251, v251, v249
    v_accvgpr_write_b32 a125, v251
    v_accvgpr_read_b32 v252, a126
    v_mul_f32 v252, v252, v249
    v_accvgpr_write_b32 a126, v252
    v_accvgpr_read_b32 v253, a127
    v_mul_f32 v253, v253, v249
    v_accvgpr_write_b32 a127, v253
    v_mul_f32 v208, v208, v249
    v_mul_f32 v209, v209, v249
    v_mul_f32 v210, v210, v249
    v_mul_f32 v211, v211, v249
    v_exp_f32 v32, v104
    v_exp_f32 v33, v105
    v_exp_f32 v34, v106
    v_cvt_pk_bf16_f32 v60, v32, v33
    v_exp_f32 v35, v107
    v_exp_f32 v36, v108
    v_cvt_pk_bf16_f32 v61, v34, v35
    v_exp_f32 v37, v109
    v_exp_f32 v38, v110
    v_cvt_pk_bf16_f32 v62, v36, v37
    v_exp_f32 v39, v111
    s_nop 0
    v_cvt_pk_bf16_f32 v63, v38, v39
    v_mov_b32 v32, v240
    v_mov_b32 v33, v241
    v_mov_b32 v34, v242
    v_mov_b32 v35, v243
    v_mov_b32 v36, v244
    v_mov_b32 v37, v245
    v_mov_b32 v38, v246
    v_mov_b32 v39, v247
    s_nop 3
    s_setpc_b64 s[52:53]
CODE_END:
.section .rodata,"a"
.p2align 6
.amdhsa_kernel standalone__tree_speculative_verify_tree_attention_over_candidate_token_tree__sampling_kernel
  .amdhsa_next_free_vgpr 512
  .amdhsa_next_free_sgpr 100
  .amdhsa_accum_offset 256
  .amdhsa_group_segment_fixed_size 0
  .amdhsa_kernarg_size 72
  .amdhsa_user_sgpr_count 2
  .amdhsa_user_sgpr_kernarg_segment_ptr 1
  .amdhsa_system_sgpr_workgroup_id_x 1
.end_amdhsa_kernel
```
